```python
import torch

def _softmax(x, axis=-1):
    return torch.softmax(x, dim=axis)
def _gelu(x):
    return torch.nn.functional.gelu(x, approximate="tanh")
def _silu(x):
    return torch.nn.functional.silu(x)
def _sigmoid(x):
    return torch.sigmoid(x)
def _layernorm(x, axis=-1, eps=1e-5):
    m = x.mean(dim=axis, keepdim=True)
    v = x.var(dim=axis, keepdim=True, unbiased=False)
    return (x - m) / torch.sqrt(v + eps)
def _scatter_add(tgt, idx, src, axis=0):
    return tgt.clone().index_add_(axis, idx, src)
def _segment_sum(src, seg, n):
    out = torch.zeros((n,) + src.shape[1:], dtype=src.dtype)
    return out.index_add_(0, seg, src)
def _pad(x, pw):
    flat = tuple(v for pair in reversed(pw) for v in pair)
    return torch.nn.functional.pad(x, flat)

kernel_name = 'recurrent_scan__gqa_block_cached__mixer_token_mlp__decode'

def setup_inputs():

    _w = (lambda a: (lambda t: t.to(torch.bfloat16) if t.is_floating_point() else t)(torch.as_tensor(a)))
    def _A_setup():
        B, Sq, D = 8, 1, 512
        Hq, Hkv, Sk, Dh = 32, 8, 4096, 128
        assert Hq % Hkv == 0, (Hq, Hkv)
        return {
            "x": _w((lambda *s: torch.randn(*s, dtype=torch.bfloat16) * 0.4)(B, Sq, D)),
            "k_cache": _w((lambda *s: torch.randn(*s, dtype=torch.bfloat16) * 1.6)(B, Hkv, Sk, Dh)),
            "v_cache": _w((lambda *s: torch.randn(*s, dtype=torch.bfloat16) * 1.6)(B, Hkv, Sk, Dh)),
            "wq": _w((lambda *s: torch.randn(*s, dtype=torch.bfloat16) * 1.6)(D, Hq * Dh) * (D ** -0.5)),
            "wo": _w((lambda *s: torch.randn(*s, dtype=torch.bfloat16) * 1.6)(Hq * Dh, D) * ((Hq * Dh) ** -0.5)),
        }
    _A_in = _A_setup()

    def _B_setup():
        B, S, D, F = 8, 1, 512, 1792
        return {
            "x": _w((lambda *s: torch.randn(*s, dtype=torch.bfloat16) * 0.4)(B, S, D)),
            "w1": _w((lambda *s: torch.randn(*s, dtype=torch.bfloat16) * 1.6)(S, F) * (S ** -0.5)),
            "b1": _w((lambda *s: torch.randn(*s, dtype=torch.bfloat16) * 1.6)(F) * 0.02),
            "w2": _w((lambda *s: torch.randn(*s, dtype=torch.bfloat16) * 1.6)(F, S) * (F ** -0.5)),
            "b2": _w((lambda *s: torch.randn(*s, dtype=torch.bfloat16) * 1.6)(S) * 0.02),
        }
    _B_in = _B_setup()

    return {
        "A_x": _A_in["x"],
        "A_k_cache": _A_in["k_cache"],
        "A_v_cache": _A_in["v_cache"],
        "A_wq": _A_in["wq"],
        "A_wo": _A_in["wo"],
        "B_x": _B_in["x"],
        "B_w1": _B_in["w1"],
        "B_b1": _B_in["b1"],
        "B_w2": _B_in["w2"],
        "B_b2": _B_in["b2"],
    }

def reference(A_x, A_k_cache, A_v_cache, A_wq, A_wo, B_x, B_w1, B_b1, B_w2, B_b2):
    def _A_ref(x, k_cache, v_cache, wq, wo):
        B, Sq, D = x.shape
        Hq, Dh = 32, 128
        Hkv = k_cache.shape[1]
        rep = Hq // Hkv
        q = (lambda x, *d: x.permute(*d))((x @ wq).reshape(B, Sq, Hq, Dh), 0, 2, 1, 3)
        k = (lambda x, n, axis: torch.repeat_interleave(x, n, dim=axis))(k_cache, rep, axis=1)
        v = (lambda x, n, axis: torch.repeat_interleave(x, n, dim=axis))(v_cache, rep, axis=1)
        scores = torch.einsum("bhqd,bhkd->bhqk", q, k) * (Dh ** -0.5)
        p = _softmax(scores, axis=-1)
        o = torch.einsum("bhqk,bhkd->bhqd", p, v)
        return (lambda x, *d: x.permute(*d))(o, 0, 2, 1, 3).reshape(B, Sq, Hq * Dh) @ wo

    def _B_ref(x, w1, b1, w2, b2):
        B, S, D = x.shape
        h = _layernorm(x, axis=-1)
        u = torch.einsum("bsd,sf->bdf", h, w1) + b1
        u = _gelu(u)
        y = torch.einsum("bdf,fs->bds", u, w2) + b2
        return (lambda x, *d: x.permute(*d))(y, 0, 2, 1)

    x = A_x
    xn = _layernorm(x, axis=-1)
    s = _A_ref(xn, A_k_cache, A_v_cache, A_wq, A_wo)
    g = _silu(_B_ref(xn, B_w1, B_b1, B_w2, B_b2))
    return x + s * g
```

```asm
; @launch grid=(256,1,1) block=(512,1,1) lds=161280
.amdgcn_target "amdgcn-amd-amdhsa--gfx950"
.text
.globl recurrent_scan__gqa_block_cached__mixer_token_mlp__decode_kernel
.p2align 8
.type recurrent_scan__gqa_block_cached__mixer_token_mlp__decode_kernel,@function
recurrent_scan__gqa_block_cached__mixer_token_mlp__decode_kernel:
    s_cmp_ge_u32 s2, 256
    s_cbranch_scc1 L_end
    s_load_dwordx2 s[44:45], s[0:1], 8
    s_load_dwordx2 s[48:49], s[0:1], 16
    v_lshrrev_b32 v1, 6, v0
    v_and_b32 v0, 63, v0
    v_readfirstlane_b32 s3, v1
    s_nop 0
    s_cmp_lg_u32 s3, 4
    s_cbranch_scc1 L_rest
    s_setprio 3
    s_lshr_b32 s4, s2, 5
    s_and_b32 s7, s2, 7
    s_bfe_u32 s6, s2, 0x20003
    s_lshl_b32 s5, s4, 23
    s_lshl2_add_u32 s6, s7, s6
    v_lshrrev_b32 v2, 4, v0
    v_and_b32 v5, 15, v0
    s_lshl_b32 s7, s7, 20
    s_bfe_u32 s6, s2, 0x20003
    s_mul_i32 s6, s6, 512
    s_add_u32 s6, s6, s7
    v_xor_b32 v9, v2, v5
    v_bfe_u32 v10, v0, 4, 1
    v_lshrrev_b32 v8, 5, v0
    v_lshlrev_b32 v8, 11, v8
    v_lshl_add_u32 v8, v10, 8, v8
    s_add_u32 s9, s5, s7
    s_sub_u32 s6, s6, s7
    s_and_b32 s7, s2, 7
    s_mul_i32 s7, s7, 0
    s_mul_i32 s5, s4, 8
    s_add_u32 s5, s5, s7
    s_and_b32 s5, s5, 63
    s_lshl_b32 s5, s5, 14
    s_add_u32 s5, s5, s6
    v_lshl_add_u32 v17, v9, 4, v8
    s_mov_b32 s46, 0x100000
    s_mov_b32 s47, 0x20000
    s_mov_b32 m0, 0
    v_xor_b32 v18, 64, v17
    v_xor_b32 v19, 128, v17
    v_xor_b32 v20, 192, v17
    v_add_u32 v18, 3072, v18
    v_add_u32 v19, 6144, v19
    v_add_u32 v20, 9216, v20
    s_waitcnt lgkmcnt(0)
    s_add_u32 s44, s44, s9
    s_addc_u32 s45, s45, 0
L_first:
    buffer_load_dwordx4 v17, s[44:47], s5 offen offset:0 nt lds
    buffer_load_dwordx4 v18, s[44:47], s5 offen offset:1024 nt lds
    buffer_load_dwordx4 v19, s[44:47], s5 offen offset:2048 nt lds
    buffer_load_dwordx4 v20, s[44:47], s5 offen offset:3072 nt lds
    s_addk_i32 m0, 4096
    s_addk_i32 s5, 16384
    s_and_b32 s5, s5, 0xfffff
    s_cmpk_lt_u32 m0, 0x8000
    s_cbranch_scc1 L_first
    s_branch L_loader2
L_rest:
    s_load_dwordx2 s[52:53], s[0:1], 0
    s_load_dwordx2 s[56:57], s[0:1], 24
    s_load_dwordx2 s[84:85], s[0:1], 96
    s_load_dwordx2 s[60:61], s[0:1], 32
    s_load_dwordx2 s[64:65], s[0:1], 48
    s_load_dwordx2 s[68:69], s[0:1], 56
    s_load_dwordx2 s[72:73], s[0:1], 64
    s_load_dwordx2 s[76:77], s[0:1], 80
    s_load_dwordx2 s[96:97], s[0:1], 72
    s_mov_b32 s54, 0x2000
    s_mov_b32 s55, 0x20000
    s_mov_b32 s58, 0x400000
    s_mov_b32 s59, 0x20000
    s_mov_b32 s86, 0x10000000
    s_mov_b32 s87, 0x20000
    s_mov_b32 s62, 0x400000
    s_mov_b32 s63, 0x20000
    s_mov_b32 s66, 0xe00
    s_mov_b32 s67, 0x20000
    s_mov_b32 s70, 0xe00
    s_mov_b32 s71, 0x20000
    s_mov_b32 s74, 0xe00
    s_mov_b32 s75, 0x20000
    s_mov_b32 s78, 0x2000
    s_mov_b32 s79, 0x20000
    s_and_b32 s9, s2, 7
    s_lshl_b32 s9, s9, 5
    s_lshr_b32 s6, s2, 3
    s_add_u32 s9, s9, s6
    s_add_u32 s6, s9, 0
    s_and_b32 s6, s6, 0x1c
    s_and_b32 s15, s9, 0xe3
    s_or_b32 s15, s15, s6
    v_lshlrev_b32 v1, 4, v0
    v_lshrrev_b32 v2, 4, v0
    v_bfe_u32 v3, v0, 2, 2
    v_and_b32 v4, 3, v0
    v_and_b32 v5, 15, v0
    v_mov_b32 v6, 0x20000
    v_mov_b32 v7, 1
    s_mov_b32 s90, 0xffff0000
    s_mov_b32 s92, 0x3fb8aa3b
    s_cmp_eq_u32 s3, 5
    s_cbranch_scc1 L_comm
    s_cmp_gt_u32 s3, 5
    s_cbranch_scc1 L_mlp
    v_lshlrev_b32 v8, 5, v0
    v_lshrrev_b32 v9, 1, v0
    v_lshlrev_b32 v9, 13, v9
    v_and_b32 v10, 1, v0
    v_lshl_add_u32 v9, v10, 4, v9
    s_lshl_b32 s8, s3, 11
    s_lshl_b32 s6, s3, 20
    s_lshl_b32 s7, s15, 5
    s_add_u32 s6, s6, s7
    v_lshrrev_b32 v9, 3, v0
    v_lshlrev_b32 v9, 13, v9
    v_and_b32 v10, 7, v0
    v_lshl_add_u32 v9, v10, 4, v9
    s_and_b32 s6, s15, 3
    s_lshl_b32 s6, s6, 20
    s_lshl_b32 s7, s3, 18
    s_add_u32 s6, s6, s7
    s_lshr_b32 s7, s15, 2
    s_lshl_b32 s7, s7, 7
    s_add_u32 s6, s6, s7
    s_lshl_b32 s7, s3, 12
    s_add_u32 s7, s7, 131072
    s_waitcnt lgkmcnt(0)
    buffer_load_dwordx4 v[48:51], v8, s[52:55], s8 offen
    buffer_load_dwordx4 v[52:55], v8, s[52:55], s8 offen offset:16
    s_add_u32 m0, s7, 0
    s_nop 0
    buffer_load_dwordx4 v9, s[56:59], s6 offen nt lds
    s_add_u32 s6, s6, 0x10000
    s_add_u32 m0, s7, 1024
    s_nop 0
    buffer_load_dwordx4 v9, s[56:59], s6 offen nt lds
    s_add_u32 s6, s6, 0x10000
    s_add_u32 m0, s7, 2048
    s_nop 0
    buffer_load_dwordx4 v9, s[56:59], s6 offen nt lds
    s_add_u32 s6, s6, 0x10000
    s_add_u32 m0, s7, 3072
    s_nop 0
    buffer_load_dwordx4 v9, s[56:59], s6 offen nt lds
    s_load_dwordx2 s[4:5], s[84:85], 0
    s_barrier
    s_mov_b32 s91, 0x3db504f3
    s_lshr_b32 s6, s9, 5
    s_lshl_b32 s6, s6, 16
    s_and_b32 s8, s9, 31
    s_lshl_b32 s8, s8, 9
    s_add_u32 s6, s6, s8
    s_add_u32 s98, s6, 0x80000
    s_and_b32 s6, s9, 7
    s_lshl_b32 s6, s6, 2
    s_add_u32 s6, s6, s3
    s_lshl_b32 s6, s6, 11
    s_lshr_b32 s8, s9, 3
    s_lshl_b32 s8, s8, 6
    s_add_u32 s6, s6, s8
    s_add_u32 s99, s6, 0x100000
    v_lshrrev_b32 v11, 5, v0
    s_lshl_b32 s6, s3, 1
    v_add_u32 v11, s6, v11
    v_mul_u32_u24 v11, 1040, v11
    v_and_b32 v12, 31, v0
    v_lshl_add_u32 v11, v12, 5, v11
    v_add_u32 v11, v6, v11
    v_and_b32 v14, 7, v0
    v_mul_u32_u24 v12, 1040, v14
    v_lshl_add_u32 v12, v2, 4, v12
    s_and_b32 s8, s15, 3
    s_lshl_b32 s6, s8, 8
    s_add_u32 s6, s6, 131072
    v_add_u32 v12, s6, v12
    v_lshl_add_u32 v13, v2, 3, v3
    v_lshlrev_b32 v13, 7, v13
    v_lshl_add_u32 v13, v4, 3, v13
    s_lshl_b32 s6, s3, 5
    s_add_u32 s6, s6, 131072
    v_add_u32 v13, s6, v13
    v_mul_u32_u24 v14, 272, v14
    v_lshl_add_u32 v14, v2, 4, v14
    s_lshl_b32 s6, s3, 6
    s_add_u32 s6, s6, 131072
    v_add_u32 v14, s6, v14
    s_lshr_b32 s6, s15, 5
    s_lshl2_add_u32 s6, s6, s8
    s_lshl_b32 s97, s6, 11
    s_bfe_u32 s6, s15, 0x30002
    s_lshl2_add_u32 s6, s6, s3
    s_lshl_b32 s6, s6, 6
    s_add_u32 s97, s97, s6
    s_add_u32 s97, s97, 0x280000
    s_lshl_b32 s6, s3, 13
    v_lshlrev_b32 v8, 8, v5
    v_add_u32 v8, s6, v8
    v_add_u32 v9, 0, v2
    v_xor_b32 v9, v9, v5
    v_lshl_add_u32 v17, v9, 4, v8
    v_add_u32 v21, 0x10000, v17
    v_add_u32 v9, 4, v2
    v_xor_b32 v9, v9, v5
    v_lshl_add_u32 v18, v9, 4, v8
    v_add_u32 v22, 0x10000, v18
    v_add_u32 v9, 8, v2
    v_xor_b32 v9, v9, v5
    v_lshl_add_u32 v19, v9, 4, v8
    v_add_u32 v23, 0x10000, v19
    v_add_u32 v9, 12, v2
    v_xor_b32 v9, v9, v5
    v_lshl_add_u32 v20, v9, 4, v8
    v_add_u32 v24, 0x10000, v20
    s_lshl_b32 s6, s3, 2
    s_add_u32 s6, s6, 131072
    v_mov_b32 v30, s6
    s_mov_b32 s101, 0
    v_mov_b32 v31, 4
    s_waitcnt vmcnt(4)
    v_lshlrev_b32 v56, 16, v48
    v_and_b32 v57, s90, v48
    v_lshlrev_b32 v58, 16, v49
    v_and_b32 v59, s90, v49
    v_lshlrev_b32 v60, 16, v50
    v_and_b32 v61, s90, v50
    v_lshlrev_b32 v62, 16, v51
    v_and_b32 v63, s90, v51
    v_lshlrev_b32 v64, 16, v52
    v_and_b32 v65, s90, v52
    v_lshlrev_b32 v66, 16, v53
    v_and_b32 v67, s90, v53
    v_lshlrev_b32 v68, 16, v54
    v_and_b32 v69, s90, v54
    v_lshlrev_b32 v70, 16, v55
    v_and_b32 v71, s90, v55
    v_add_f32 v88, v56, v57
    v_add_f32 v89, v58, v59
    v_add_f32 v88, v88, v60
    v_add_f32 v89, v89, v61
    v_add_f32 v88, v88, v62
    v_add_f32 v89, v89, v63
    v_add_f32 v88, v88, v64
    v_add_f32 v89, v89, v65
    v_add_f32 v88, v88, v66
    v_add_f32 v89, v89, v67
    v_add_f32 v88, v88, v68
    v_add_f32 v89, v89, v69
    v_add_f32 v88, v88, v70
    v_add_f32 v89, v89, v71
    v_add_f32 v88, v88, v89
    s_nop 1
    v_add_f32_dpp v88, v88, v88 quad_perm:[1,0,3,2] row_mask:0xf bank_mask:0xf
    s_nop 1
    v_add_f32_dpp v88, v88, v88 quad_perm:[2,3,0,1] row_mask:0xf bank_mask:0xf
    s_nop 1
    v_add_f32_dpp v88, v88, v88 row_half_mirror row_mask:0xf bank_mask:0xf
    s_nop 1
    v_add_f32_dpp v88, v88, v88 row_mirror row_mask:0xf bank_mask:0xf
    v_mov_b32 v90, v88
    s_nop 1
    v_permlane16_swap_b32 v88, v90
    v_add_f32 v88, v88, v90
    v_mul_f32 v88, 0x3b000000, v88
    v_cvt_pk_bf16_f32 v89, v88, v88
    v_sub_f32 v72, v56, v88
    v_sub_f32 v73, v57, v88
    v_sub_f32 v74, v58, v88
    v_sub_f32 v75, v59, v88
    v_sub_f32 v76, v60, v88
    v_sub_f32 v77, v61, v88
    v_sub_f32 v78, v62, v88
    v_sub_f32 v79, v63, v88
    v_sub_f32 v80, v64, v88
    v_sub_f32 v81, v65, v88
    v_sub_f32 v82, v66, v88
    v_sub_f32 v83, v67, v88
    v_sub_f32 v84, v68, v88
    v_sub_f32 v85, v69, v88
    v_sub_f32 v86, v70, v88
    v_sub_f32 v87, v71, v88
    v_lshlrev_b32 v89, 16, v89
    v_mul_f32 v88, v72, v72
    v_mul_f32 v72, v73, v73
    v_fmac_f32 v72, v74, v74
    v_fmac_f32 v88, v75, v75
    v_fmac_f32 v72, v76, v76
    v_fmac_f32 v88, v77, v77
    v_fmac_f32 v72, v78, v78
    v_fmac_f32 v88, v79, v79
    v_fmac_f32 v72, v80, v80
    v_fmac_f32 v88, v81, v81
    v_fmac_f32 v72, v82, v82
    v_fmac_f32 v88, v83, v83
    v_fmac_f32 v72, v84, v84
    v_fmac_f32 v88, v85, v85
    v_fmac_f32 v72, v86, v86
    v_fmac_f32 v88, v87, v87
    v_add_f32 v88, v88, v72
    v_sub_f32 v56, v56, v89
    v_sub_f32 v57, v57, v89
    v_sub_f32 v58, v58, v89
    v_sub_f32 v59, v59, v89
    v_sub_f32 v60, v60, v89
    v_sub_f32 v61, v61, v89
    v_sub_f32 v62, v62, v89
    v_sub_f32 v63, v63, v89
    v_sub_f32 v64, v64, v89
    v_sub_f32 v65, v65, v89
    v_sub_f32 v66, v66, v89
    v_sub_f32 v67, v67, v89
    v_sub_f32 v68, v68, v89
    v_sub_f32 v69, v69, v89
    v_sub_f32 v70, v70, v89
    v_sub_f32 v71, v71, v89
    v_add_f32_dpp v88, v88, v88 quad_perm:[1,0,3,2] row_mask:0xf bank_mask:0xf
    s_nop 1
    v_add_f32_dpp v88, v88, v88 quad_perm:[2,3,0,1] row_mask:0xf bank_mask:0xf
    s_nop 1
    v_add_f32_dpp v88, v88, v88 row_half_mirror row_mask:0xf bank_mask:0xf
    s_nop 1
    v_add_f32_dpp v88, v88, v88 row_mirror row_mask:0xf bank_mask:0xf
    v_mov_b32 v90, v88
    s_nop 1
    v_permlane16_swap_b32 v88, v90
    v_add_f32 v88, v88, v90
    v_cvt_pk_bf16_f32 v48, v56, v57
    v_cvt_pk_bf16_f32 v49, v58, v59
    v_cvt_pk_bf16_f32 v50, v60, v61
    v_cvt_pk_bf16_f32 v51, v62, v63
    v_cvt_pk_bf16_f32 v52, v64, v65
    v_cvt_pk_bf16_f32 v53, v66, v67
    v_cvt_pk_bf16_f32 v54, v68, v69
    v_cvt_pk_bf16_f32 v55, v70, v71
    v_mul_f32 v88, 0x3b000000, v88
    v_cvt_pk_bf16_f32 v88, v88, v88
    v_lshlrev_b32 v88, 16, v88
    v_add_f32 v88, 0x3727c5ac, v88
    v_cvt_pk_bf16_f32 v88, v88, v88
    v_lshlrev_b32 v88, 16, v88
    v_sqrt_f32 v88, v88
    s_nop 0
    v_cvt_pk_bf16_f32 v88, v88, v88
    v_lshlrev_b32 v88, 16, v88
    v_rcp_f32 v88, v88
    v_lshlrev_b32 v56, 16, v48
    v_and_b32 v57, s90, v48
    v_lshlrev_b32 v58, 16, v49
    v_and_b32 v59, s90, v49
    v_lshlrev_b32 v60, 16, v50
    v_and_b32 v61, s90, v50
    v_lshlrev_b32 v62, 16, v51
    v_and_b32 v63, s90, v51
    v_lshlrev_b32 v64, 16, v52
    v_and_b32 v65, s90, v52
    v_lshlrev_b32 v66, 16, v53
    v_and_b32 v67, s90, v53
    v_lshlrev_b32 v68, 16, v54
    v_and_b32 v69, s90, v54
    v_lshlrev_b32 v70, 16, v55
    v_and_b32 v71, s90, v55
    v_mul_f32 v56, v88, v56
    v_mul_f32 v57, v88, v57
    v_mul_f32 v58, v88, v58
    v_mul_f32 v59, v88, v59
    v_mul_f32 v60, v88, v60
    v_mul_f32 v61, v88, v61
    v_mul_f32 v62, v88, v62
    v_mul_f32 v63, v88, v63
    v_mul_f32 v64, v88, v64
    v_mul_f32 v65, v88, v65
    v_mul_f32 v66, v88, v66
    v_mul_f32 v67, v88, v67
    v_mul_f32 v68, v88, v68
    v_mul_f32 v69, v88, v69
    v_mul_f32 v70, v88, v70
    v_mul_f32 v71, v88, v71
    v_cvt_pk_bf16_f32 v48, v56, v57
    v_cvt_pk_bf16_f32 v49, v58, v59
    v_cvt_pk_bf16_f32 v50, v60, v61
    v_cvt_pk_bf16_f32 v51, v62, v63
    v_cvt_pk_bf16_f32 v52, v64, v65
    v_cvt_pk_bf16_f32 v53, v66, v67
    v_cvt_pk_bf16_f32 v54, v68, v69
    v_cvt_pk_bf16_f32 v55, v70, v71
    ds_write_b128 v11, v[48:51] offset:16384
    ds_write_b128 v11, v[52:55] offset:16400
    s_waitcnt lgkmcnt(0)
    s_mov_b64 exec, 1
    ds_add_u32 v6, v7 offset:29872
    s_mov_b64 exec, -1
    s_add_u32 s4, s4, 0x7f4a7c15
    s_addc_u32 s5, s5, 0x9e3779b9
    v_mov_b32 v8, s4
    v_mov_b32 v9, s5
    v_and_b32 v10, 1, v2
    v_cmp_eq_u32 vcc, 1, v10
    s_nop 1
    v_cndmask_b32 v8, v8, v9, vcc
    s_mov_b32 s80, 0x7060500
    s_mov_b32 s81, 0x7060501
    s_mov_b32 s82, 0x7060502
    s_mov_b32 s83, 0x7060503
    s_waitcnt vmcnt(0)
    s_waitcnt lgkmcnt(0)
    s_mov_b64 exec, 1
    ds_add_u32 v6, v7 offset:29876
    s_mov_b64 exec, -1
    s_mov_b32 s10, 0
L_lagain_6:
    ds_read_b32 v16, v6 offset:29872
    s_waitcnt lgkmcnt(0)
    v_readfirstlane_b32 s11, v16
    s_nop 0
    s_cmp_ge_u32 s11, 4
    s_cbranch_scc1 L_lok_5
    s_sleep 1
    s_add_u32 s10, s10, 1
    s_cmp_lt_u32 s10, 4194304
    s_cbranch_scc1 L_lagain_6
L_lok_5:
    ds_read_b128 v[144:147], v12 offset:16384
    ds_read_b128 v[148:151], v12 offset:16448
    ds_read_b128 v[152:155], v12 offset:16512
    ds_read_b128 v[156:159], v12 offset:16576
    s_mov_b32 s10, 0
L_lagain_8:
    ds_read_b32 v16, v6 offset:29876
    s_waitcnt lgkmcnt(0)
    v_readfirstlane_b32 s11, v16
    s_nop 0
    s_cmp_ge_u32 s11, 4
    s_cbranch_scc1 L_lok_7
    s_sleep 1
    s_add_u32 s10, s10, 1
    s_cmp_lt_u32 s10, 4194304
    s_cbranch_scc1 L_lagain_8
L_lok_7:
    ds_read_b64_tr_b16 v[128:129], v13 offset:0
    ds_read_b64_tr_b16 v[130:131], v13 offset:512
    ds_read_b64_tr_b16 v[132:133], v13 offset:4096
    ds_read_b64_tr_b16 v[134:135], v13 offset:4608
    ds_read_b64_tr_b16 v[136:137], v13 offset:8192
    ds_read_b64_tr_b16 v[138:139], v13 offset:8704
    ds_read_b64_tr_b16 v[140:141], v13 offset:12288
    ds_read_b64_tr_b16 v[142:143], v13 offset:12800
    s_waitcnt lgkmcnt(6)
    v_mfma_f32_16x16x32_bf16 v[112:115], v[128:131], v[144:147], 0
    s_waitcnt lgkmcnt(4)
    v_mfma_f32_16x16x32_bf16 v[112:115], v[132:135], v[148:151], v[112:115]
    s_waitcnt lgkmcnt(2)
    v_mfma_f32_16x16x32_bf16 v[112:115], v[136:139], v[152:155], v[112:115]
    s_waitcnt lgkmcnt(0)
    v_mfma_f32_16x16x32_bf16 v[112:115], v[140:143], v[156:159], v[112:115]
    s_nop 7
    v_perm_b32 v112, v112, v8, s80
    v_perm_b32 v113, v113, v8, s81
    v_perm_b32 v114, v114, v8, s82
    v_perm_b32 v115, v115, v8, s83
    s_mov_b32 exec_lo, 0x00ff00ff
    s_mov_b32 exec_hi, 0x00ff00ff
    ds_write_b128 v14, v[112:115] offset:24704
    s_mov_b64 exec, -1
    s_waitcnt lgkmcnt(0)
    s_mov_b64 exec, 1
    ds_add_u32 v6, v7 offset:29876
    s_mov_b64 exec, -1
L_qdone:
    s_add_u32 s6, s3, 1
    s_cmp_ge_u32 s101, s6
    s_cbranch_scc1 L_lok_9
    s_mov_b32 s10, 0
L_lagain_10:
    ds_read_b32 v16, v6 offset:29824
    s_waitcnt lgkmcnt(0)
    v_readfirstlane_b32 s101, v16
    s_nop 0
    s_cmp_ge_u32 s101, s6
    s_cbranch_scc1 L_lok_9
    s_sleep 1
    s_add_u32 s10, s10, 1
    s_cmp_lt_u32 s10, 4194304
    s_cbranch_scc1 L_lagain_10
L_lok_9:
    ds_read_b128 v[128:131], v17 offset:0
    ds_read_b128 v[132:135], v18 offset:0
    ds_read_b128 v[136:139], v19 offset:0
    ds_read_b128 v[140:143], v20 offset:0
    ds_read_b128 v[144:147], v17 offset:4096
    ds_read_b128 v[148:151], v18 offset:4096
    ds_read_b128 v[152:155], v19 offset:4096
    ds_read_b128 v[156:159], v20 offset:4096
    s_waitcnt lgkmcnt(0)
    s_mov_b64 exec, 1
    ds_add_u32 v30, v31 offset:29840
    s_mov_b64 exec, -1
    s_add_u32 s6, s3, 5
    s_cmp_ge_u32 s101, s6
    s_cbranch_scc1 L_lok_11
    s_mov_b32 s10, 0
L_lagain_12:
    ds_read_b32 v16, v6 offset:29824
    s_waitcnt lgkmcnt(0)
    v_readfirstlane_b32 s101, v16
    s_nop 0
    s_cmp_ge_u32 s101, s6
    s_cbranch_scc1 L_lok_11
    s_sleep 1
    s_add_u32 s10, s10, 1
    s_cmp_lt_u32 s10, 4194304
    s_cbranch_scc1 L_lagain_12
L_lok_11:
    ds_read_b128 v[160:163], v17 offset:32768
    ds_read_b128 v[164:167], v18 offset:32768
    ds_read_b128 v[168:171], v19 offset:32768
    ds_read_b128 v[172:175], v20 offset:32768
    ds_read_b128 v[176:179], v17 offset:36864
    ds_read_b128 v[180:183], v18 offset:36864
    ds_read_b128 v[184:187], v19 offset:36864
    ds_read_b128 v[188:191], v20 offset:36864
    s_waitcnt lgkmcnt(0)
    s_mov_b64 exec, 1
    ds_add_u32 v30, v31 offset:29840
    s_mov_b64 exec, -1
    s_add_u32 s6, s3, 9
    s_cmp_ge_u32 s101, s6
    s_cbranch_scc1 L_lok_13
    s_mov_b32 s10, 0
L_lagain_14:
    ds_read_b32 v16, v6 offset:29824
    s_waitcnt lgkmcnt(0)
    v_readfirstlane_b32 s101, v16
    s_nop 0
    s_cmp_ge_u32 s101, s6
    s_cbranch_scc1 L_lok_13
    s_sleep 1
    s_add_u32 s10, s10, 1
    s_cmp_lt_u32 s10, 4194304
    s_cbranch_scc1 L_lagain_14
L_lok_13:
    ds_read_b128 v[192:195], v21 offset:0
    ds_read_b128 v[196:199], v22 offset:0
    ds_read_b128 v[200:203], v23 offset:0
    ds_read_b128 v[204:207], v24 offset:0
    ds_read_b128 v[208:211], v21 offset:4096
    ds_read_b128 v[212:215], v22 offset:4096
    ds_read_b128 v[216:219], v23 offset:4096
    ds_read_b128 v[220:223], v24 offset:4096
    s_waitcnt lgkmcnt(0)
    s_mov_b64 exec, 1
    ds_add_u32 v30, v31 offset:29840
    s_mov_b64 exec, -1
    s_add_u32 s6, s3, 13
    s_cmp_ge_u32 s101, s6
    s_cbranch_scc1 L_lok_15
    s_mov_b32 s10, 0
L_lagain_16:
    ds_read_b32 v16, v6 offset:29824
    s_waitcnt lgkmcnt(0)
    v_readfirstlane_b32 s101, v16
    s_nop 0
    s_cmp_ge_u32 s101, s6
    s_cbranch_scc1 L_lok_15
    s_sleep 1
    s_add_u32 s10, s10, 1
    s_cmp_lt_u32 s10, 4194304
    s_cbranch_scc1 L_lagain_16
L_lok_15:
    ds_read_b128 v[224:227], v21 offset:32768
    ds_read_b128 v[228:231], v22 offset:32768
    ds_read_b128 v[232:235], v23 offset:32768
    ds_read_b128 v[236:239], v24 offset:32768
    ds_read_b128 v[240:243], v21 offset:36864
    ds_read_b128 v[244:247], v22 offset:36864
    ds_read_b128 v[248:251], v23 offset:36864
    ds_read_b128 v[252:255], v24 offset:36864
    s_waitcnt lgkmcnt(0)
    s_mov_b64 exec, 1
    ds_add_u32 v30, v31 offset:29840
    s_mov_b64 exec, -1
    s_mov_b32 s10, 0
L_lagain_18:
    ds_read_b32 v16, v6 offset:29880
    s_waitcnt lgkmcnt(0)
    v_readfirstlane_b32 s11, v16
    s_nop 0
    s_cmp_ge_u32 s11, 1
    s_cbranch_scc1 L_lok_17
    s_sleep 1
    s_add_u32 s10, s10, 1
    s_cmp_lt_u32 s10, 4194304
    s_cbranch_scc1 L_lagain_18
L_lok_17:
    v_lshlrev_b32 v8, 8, v3
    v_lshl_add_u32 v8, v2, 4, v8
    v_add_u32 v8, v6, v8
    ds_read_b128 v[32:35], v8 offset:28800
    ds_read_b128 v[36:39], v8 offset:28864
    ds_read_b128 v[40:43], v8 offset:28928
    ds_read_b128 v[44:47], v8 offset:28992
    s_waitcnt lgkmcnt(0)
    v_mfma_f32_16x16x32_bf16 v[48:51], v[128:131], v[32:35], 0
    v_mfma_f32_16x16x32_bf16 v[52:55], v[144:147], v[32:35], 0
    v_mfma_f32_16x16x32_bf16 v[48:51], v[132:135], v[36:39], v[48:51]
    v_mfma_f32_16x16x32_bf16 v[52:55], v[148:151], v[36:39], v[52:55]
    v_mfma_f32_16x16x32_bf16 v[48:51], v[136:139], v[40:43], v[48:51]
    v_mfma_f32_16x16x32_bf16 v[52:55], v[152:155], v[40:43], v[52:55]
    v_mfma_f32_16x16x32_bf16 v[48:51], v[140:143], v[44:47], v[48:51]
    v_mfma_f32_16x16x32_bf16 v[52:55], v[156:159], v[44:47], v[52:55]
    s_add_u32 s6, s3, 17
    s_cmp_ge_u32 s101, s6
    s_cbranch_scc1 L_lok_19
    s_mov_b32 s10, 0
L_lagain_20:
    ds_read_b32 v16, v6 offset:29824
    s_waitcnt lgkmcnt(0)
    v_readfirstlane_b32 s101, v16
    s_nop 0
    s_cmp_ge_u32 s101, s6
    s_cbranch_scc1 L_lok_19
    s_sleep 1
    s_add_u32 s10, s10, 1
    s_cmp_lt_u32 s10, 4194304
    s_cbranch_scc1 L_lagain_20
L_lok_19:
    s_nop 3
    ds_read_b128 v[128:131], v17 offset:0
    ds_read_b128 v[132:135], v18 offset:0
    ds_read_b128 v[136:139], v19 offset:0
    ds_read_b128 v[140:143], v20 offset:0
    ds_read_b128 v[144:147], v17 offset:4096
    ds_read_b128 v[148:151], v18 offset:4096
    ds_read_b128 v[152:155], v19 offset:4096
    ds_read_b128 v[156:159], v20 offset:4096
    s_waitcnt lgkmcnt(0)
    s_mov_b64 exec, 1
    ds_add_u32 v30, v31 offset:29840
    s_mov_b64 exec, -1
    v_mfma_f32_16x16x32_bf16 v[56:59], v[160:163], v[32:35], 0
    v_mfma_f32_16x16x32_bf16 v[60:63], v[176:179], v[32:35], 0
    v_mfma_f32_16x16x32_bf16 v[56:59], v[164:167], v[36:39], v[56:59]
    v_mfma_f32_16x16x32_bf16 v[60:63], v[180:183], v[36:39], v[60:63]
    v_mfma_f32_16x16x32_bf16 v[56:59], v[168:171], v[40:43], v[56:59]
    v_mfma_f32_16x16x32_bf16 v[60:63], v[184:187], v[40:43], v[60:63]
    v_mfma_f32_16x16x32_bf16 v[56:59], v[172:175], v[44:47], v[56:59]
    v_mfma_f32_16x16x32_bf16 v[60:63], v[188:191], v[44:47], v[60:63]
    s_add_u32 s6, s3, 21
    s_cmp_ge_u32 s101, s6
    s_cbranch_scc1 L_lok_21
    s_mov_b32 s10, 0
L_lagain_22:
    ds_read_b32 v16, v6 offset:29824
    s_waitcnt lgkmcnt(0)
    v_readfirstlane_b32 s101, v16
    s_nop 0
    s_cmp_ge_u32 s101, s6
    s_cbranch_scc1 L_lok_21
    s_sleep 1
    s_add_u32 s10, s10, 1
    s_cmp_lt_u32 s10, 4194304
    s_cbranch_scc1 L_lagain_22
L_lok_21:
    s_nop 3
    ds_read_b128 v[160:163], v17 offset:32768
    ds_read_b128 v[164:167], v18 offset:32768
    ds_read_b128 v[168:171], v19 offset:32768
    ds_read_b128 v[172:175], v20 offset:32768
    ds_read_b128 v[176:179], v17 offset:36864
    ds_read_b128 v[180:183], v18 offset:36864
    ds_read_b128 v[184:187], v19 offset:36864
    ds_read_b128 v[188:191], v20 offset:36864
    v_cvt_pk_bf16_f32 v8, v48, v49
    v_lshlrev_b32 v48, 16, v8
    v_and_b32 v49, s90, v8
    v_mul_f32 v48, s91, v48
    v_mul_f32 v49, s91, v49
    v_cvt_pk_bf16_f32 v8, v48, v49
    v_lshlrev_b32 v48, 16, v8
    v_and_b32 v49, s90, v8
    v_max_f32 v25, v48, v49
    v_cvt_pk_bf16_f32 v9, v50, v51
    v_lshlrev_b32 v50, 16, v9
    v_and_b32 v51, s90, v9
    v_mul_f32 v50, s91, v50
    v_mul_f32 v51, s91, v51
    v_cvt_pk_bf16_f32 v9, v50, v51
    v_lshlrev_b32 v50, 16, v9
    v_and_b32 v51, s90, v9
    v_max3_f32 v25, v50, v51, v25
    v_cvt_pk_bf16_f32 v8, v52, v53
    v_lshlrev_b32 v52, 16, v8
    v_and_b32 v53, s90, v8
    v_mul_f32 v52, s91, v52
    v_mul_f32 v53, s91, v53
    v_cvt_pk_bf16_f32 v8, v52, v53
    v_lshlrev_b32 v52, 16, v8
    v_and_b32 v53, s90, v8
    v_max3_f32 v25, v52, v53, v25
    v_cvt_pk_bf16_f32 v9, v54, v55
    v_lshlrev_b32 v54, 16, v9
    v_and_b32 v55, s90, v9
    v_mul_f32 v54, s91, v54
    v_mul_f32 v55, s91, v55
    v_cvt_pk_bf16_f32 v9, v54, v55
    v_lshlrev_b32 v54, 16, v9
    v_and_b32 v55, s90, v9
    v_max3_f32 v25, v54, v55, v25
    s_waitcnt lgkmcnt(0)
    s_mov_b64 exec, 1
    ds_add_u32 v30, v31 offset:29840
    s_mov_b64 exec, -1
    v_mfma_f32_16x16x32_bf16 v[64:67], v[192:195], v[32:35], 0
    v_mfma_f32_16x16x32_bf16 v[68:71], v[208:211], v[32:35], 0
    v_mfma_f32_16x16x32_bf16 v[64:67], v[196:199], v[36:39], v[64:67]
    v_mfma_f32_16x16x32_bf16 v[68:71], v[212:215], v[36:39], v[68:71]
    v_mfma_f32_16x16x32_bf16 v[64:67], v[200:203], v[40:43], v[64:67]
    v_mfma_f32_16x16x32_bf16 v[68:71], v[216:219], v[40:43], v[68:71]
    v_mfma_f32_16x16x32_bf16 v[64:67], v[204:207], v[44:47], v[64:67]
    v_mfma_f32_16x16x32_bf16 v[68:71], v[220:223], v[44:47], v[68:71]
    s_add_u32 s6, s3, 25
    s_cmp_ge_u32 s101, s6
    s_cbranch_scc1 L_lok_23
    s_mov_b32 s10, 0
L_lagain_24:
    ds_read_b32 v16, v6 offset:29824
    s_waitcnt lgkmcnt(0)
    v_readfirstlane_b32 s101, v16
    s_nop 0
    s_cmp_ge_u32 s101, s6
    s_cbranch_scc1 L_lok_23
    s_sleep 1
    s_add_u32 s10, s10, 1
    s_cmp_lt_u32 s10, 4194304
    s_cbranch_scc1 L_lagain_24
L_lok_23:
    s_nop 3
    ds_read_b128 v[192:195], v21 offset:0
    ds_read_b128 v[196:199], v22 offset:0
    ds_read_b128 v[200:203], v23 offset:0
    ds_read_b128 v[204:207], v24 offset:0
    ds_read_b128 v[208:211], v21 offset:4096
    ds_read_b128 v[212:215], v22 offset:4096
    ds_read_b128 v[216:219], v23 offset:4096
    ds_read_b128 v[220:223], v24 offset:4096
    v_cvt_pk_bf16_f32 v8, v56, v57
    v_lshlrev_b32 v56, 16, v8
    v_and_b32 v57, s90, v8
    v_mul_f32 v56, s91, v56
    v_mul_f32 v57, s91, v57
    v_cvt_pk_bf16_f32 v8, v56, v57
    v_lshlrev_b32 v56, 16, v8
    v_and_b32 v57, s90, v8
    v_max3_f32 v25, v56, v57, v25
    v_cvt_pk_bf16_f32 v9, v58, v59
    v_lshlrev_b32 v58, 16, v9
    v_and_b32 v59, s90, v9
    v_mul_f32 v58, s91, v58
    v_mul_f32 v59, s91, v59
    v_cvt_pk_bf16_f32 v9, v58, v59
    v_lshlrev_b32 v58, 16, v9
    v_and_b32 v59, s90, v9
    v_max3_f32 v25, v58, v59, v25
    v_cvt_pk_bf16_f32 v8, v60, v61
    v_lshlrev_b32 v60, 16, v8
    v_and_b32 v61, s90, v8
    v_mul_f32 v60, s91, v60
    v_mul_f32 v61, s91, v61
    v_cvt_pk_bf16_f32 v8, v60, v61
    v_lshlrev_b32 v60, 16, v8
    v_and_b32 v61, s90, v8
    v_max3_f32 v25, v60, v61, v25
    v_cvt_pk_bf16_f32 v9, v62, v63
    v_lshlrev_b32 v62, 16, v9
    v_and_b32 v63, s90, v9
    v_mul_f32 v62, s91, v62
    v_mul_f32 v63, s91, v63
    v_cvt_pk_bf16_f32 v9, v62, v63
    v_lshlrev_b32 v62, 16, v9
    v_and_b32 v63, s90, v9
    v_max3_f32 v25, v62, v63, v25
    s_waitcnt lgkmcnt(0)
    s_mov_b64 exec, 1
    ds_add_u32 v30, v31 offset:29840
    s_mov_b64 exec, -1
    v_mfma_f32_16x16x32_bf16 v[72:75], v[224:227], v[32:35], 0
    v_mfma_f32_16x16x32_bf16 v[76:79], v[240:243], v[32:35], 0
    v_mfma_f32_16x16x32_bf16 v[72:75], v[228:231], v[36:39], v[72:75]
    v_mfma_f32_16x16x32_bf16 v[76:79], v[244:247], v[36:39], v[76:79]
    v_mfma_f32_16x16x32_bf16 v[72:75], v[232:235], v[40:43], v[72:75]
    v_mfma_f32_16x16x32_bf16 v[76:79], v[248:251], v[40:43], v[76:79]
    v_mfma_f32_16x16x32_bf16 v[72:75], v[236:239], v[44:47], v[72:75]
    v_mfma_f32_16x16x32_bf16 v[76:79], v[252:255], v[44:47], v[76:79]
    s_add_u32 s6, s3, 29
    s_cmp_ge_u32 s101, s6
    s_cbranch_scc1 L_lok_25
    s_mov_b32 s10, 0
L_lagain_26:
    ds_read_b32 v16, v6 offset:29824
    s_waitcnt lgkmcnt(0)
    v_readfirstlane_b32 s101, v16
    s_nop 0
    s_cmp_ge_u32 s101, s6
    s_cbranch_scc1 L_lok_25
    s_sleep 1
    s_add_u32 s10, s10, 1
    s_cmp_lt_u32 s10, 4194304
    s_cbranch_scc1 L_lagain_26
L_lok_25:
    s_nop 3
    ds_read_b128 v[224:227], v21 offset:32768
    ds_read_b128 v[228:231], v22 offset:32768
    ds_read_b128 v[232:235], v23 offset:32768
    ds_read_b128 v[236:239], v24 offset:32768
    ds_read_b128 v[240:243], v21 offset:36864
    ds_read_b128 v[244:247], v22 offset:36864
    ds_read_b128 v[248:251], v23 offset:36864
    ds_read_b128 v[252:255], v24 offset:36864
    v_cvt_pk_bf16_f32 v8, v64, v65
    v_lshlrev_b32 v64, 16, v8
    v_and_b32 v65, s90, v8
    v_mul_f32 v64, s91, v64
    v_mul_f32 v65, s91, v65
    v_cvt_pk_bf16_f32 v8, v64, v65
    v_lshlrev_b32 v64, 16, v8
    v_and_b32 v65, s90, v8
    v_max3_f32 v25, v64, v65, v25
    v_cvt_pk_bf16_f32 v9, v66, v67
    v_lshlrev_b32 v66, 16, v9
    v_and_b32 v67, s90, v9
    v_mul_f32 v66, s91, v66
    v_mul_f32 v67, s91, v67
    v_cvt_pk_bf16_f32 v9, v66, v67
    v_lshlrev_b32 v66, 16, v9
    v_and_b32 v67, s90, v9
    v_max3_f32 v25, v66, v67, v25
    v_cvt_pk_bf16_f32 v8, v68, v69
    v_lshlrev_b32 v68, 16, v8
    v_and_b32 v69, s90, v8
    v_mul_f32 v68, s91, v68
    v_mul_f32 v69, s91, v69
    v_cvt_pk_bf16_f32 v8, v68, v69
    v_lshlrev_b32 v68, 16, v8
    v_and_b32 v69, s90, v8
    v_max3_f32 v25, v68, v69, v25
    v_cvt_pk_bf16_f32 v9, v70, v71
    v_lshlrev_b32 v70, 16, v9
    v_and_b32 v71, s90, v9
    v_mul_f32 v70, s91, v70
    v_mul_f32 v71, s91, v71
    v_cvt_pk_bf16_f32 v9, v70, v71
    v_lshlrev_b32 v70, 16, v9
    v_and_b32 v71, s90, v9
    v_max3_f32 v25, v70, v71, v25
    s_waitcnt lgkmcnt(0)
    s_mov_b64 exec, 1
    ds_add_u32 v30, v31 offset:29840
    s_mov_b64 exec, -1
    v_mfma_f32_16x16x32_bf16 v[80:83], v[128:131], v[32:35], 0
    v_mfma_f32_16x16x32_bf16 v[84:87], v[144:147], v[32:35], 0
    v_mfma_f32_16x16x32_bf16 v[80:83], v[132:135], v[36:39], v[80:83]
    v_mfma_f32_16x16x32_bf16 v[84:87], v[148:151], v[36:39], v[84:87]
    v_mfma_f32_16x16x32_bf16 v[80:83], v[136:139], v[40:43], v[80:83]
    v_mfma_f32_16x16x32_bf16 v[84:87], v[152:155], v[40:43], v[84:87]
    v_mfma_f32_16x16x32_bf16 v[80:83], v[140:143], v[44:47], v[80:83]
    v_mfma_f32_16x16x32_bf16 v[84:87], v[156:159], v[44:47], v[84:87]
    v_cvt_pk_bf16_f32 v8, v72, v73
    v_lshlrev_b32 v72, 16, v8
    v_and_b32 v73, s90, v8
    v_mul_f32 v72, s91, v72
    v_mul_f32 v73, s91, v73
    v_cvt_pk_bf16_f32 v8, v72, v73
    v_lshlrev_b32 v72, 16, v8
    v_and_b32 v73, s90, v8
    v_max3_f32 v25, v72, v73, v25
    v_cvt_pk_bf16_f32 v9, v74, v75
    v_lshlrev_b32 v74, 16, v9
    v_and_b32 v75, s90, v9
    v_mul_f32 v74, s91, v74
    v_mul_f32 v75, s91, v75
    v_cvt_pk_bf16_f32 v9, v74, v75
    v_lshlrev_b32 v74, 16, v9
    v_and_b32 v75, s90, v9
    v_max3_f32 v25, v74, v75, v25
    v_cvt_pk_bf16_f32 v8, v76, v77
    v_lshlrev_b32 v76, 16, v8
    v_and_b32 v77, s90, v8
    v_mul_f32 v76, s91, v76
    v_mul_f32 v77, s91, v77
    v_cvt_pk_bf16_f32 v8, v76, v77
    v_lshlrev_b32 v76, 16, v8
    v_and_b32 v77, s90, v8
    v_max3_f32 v25, v76, v77, v25
    v_cvt_pk_bf16_f32 v9, v78, v79
    v_lshlrev_b32 v78, 16, v9
    v_and_b32 v79, s90, v9
    v_mul_f32 v78, s91, v78
    v_mul_f32 v79, s91, v79
    v_cvt_pk_bf16_f32 v9, v78, v79
    v_lshlrev_b32 v78, 16, v9
    v_and_b32 v79, s90, v9
    v_max3_f32 v25, v78, v79, v25
    v_mfma_f32_16x16x32_bf16 v[88:91], v[160:163], v[32:35], 0
    v_mfma_f32_16x16x32_bf16 v[92:95], v[176:179], v[32:35], 0
    v_mfma_f32_16x16x32_bf16 v[88:91], v[164:167], v[36:39], v[88:91]
    v_mfma_f32_16x16x32_bf16 v[92:95], v[180:183], v[36:39], v[92:95]
    v_mfma_f32_16x16x32_bf16 v[88:91], v[168:171], v[40:43], v[88:91]
    v_mfma_f32_16x16x32_bf16 v[92:95], v[184:187], v[40:43], v[92:95]
    v_mfma_f32_16x16x32_bf16 v[88:91], v[172:175], v[44:47], v[88:91]
    v_mfma_f32_16x16x32_bf16 v[92:95], v[188:191], v[44:47], v[92:95]
    v_cvt_pk_bf16_f32 v8, v80, v81
    v_lshlrev_b32 v80, 16, v8
    v_and_b32 v81, s90, v8
    v_mul_f32 v80, s91, v80
    v_mul_f32 v81, s91, v81
    v_cvt_pk_bf16_f32 v8, v80, v81
    v_lshlrev_b32 v80, 16, v8
    v_and_b32 v81, s90, v8
    v_max3_f32 v25, v80, v81, v25
    v_cvt_pk_bf16_f32 v9, v82, v83
    v_lshlrev_b32 v82, 16, v9
    v_and_b32 v83, s90, v9
    v_mul_f32 v82, s91, v82
    v_mul_f32 v83, s91, v83
    v_cvt_pk_bf16_f32 v9, v82, v83
    v_lshlrev_b32 v82, 16, v9
    v_and_b32 v83, s90, v9
    v_max3_f32 v25, v82, v83, v25
    v_cvt_pk_bf16_f32 v8, v84, v85
    v_lshlrev_b32 v84, 16, v8
    v_and_b32 v85, s90, v8
    v_mul_f32 v84, s91, v84
    v_mul_f32 v85, s91, v85
    v_cvt_pk_bf16_f32 v8, v84, v85
    v_lshlrev_b32 v84, 16, v8
    v_and_b32 v85, s90, v8
    v_max3_f32 v25, v84, v85, v25
    v_cvt_pk_bf16_f32 v9, v86, v87
    v_lshlrev_b32 v86, 16, v9
    v_and_b32 v87, s90, v9
    v_mul_f32 v86, s91, v86
    v_mul_f32 v87, s91, v87
    v_cvt_pk_bf16_f32 v9, v86, v87
    v_lshlrev_b32 v86, 16, v9
    v_and_b32 v87, s90, v9
    v_max3_f32 v25, v86, v87, v25
    v_mfma_f32_16x16x32_bf16 v[96:99], v[192:195], v[32:35], 0
    v_mfma_f32_16x16x32_bf16 v[100:103], v[208:211], v[32:35], 0
    v_mfma_f32_16x16x32_bf16 v[96:99], v[196:199], v[36:39], v[96:99]
    v_mfma_f32_16x16x32_bf16 v[100:103], v[212:215], v[36:39], v[100:103]
    v_mfma_f32_16x16x32_bf16 v[96:99], v[200:203], v[40:43], v[96:99]
    v_mfma_f32_16x16x32_bf16 v[100:103], v[216:219], v[40:43], v[100:103]
    v_mfma_f32_16x16x32_bf16 v[96:99], v[204:207], v[44:47], v[96:99]
    v_mfma_f32_16x16x32_bf16 v[100:103], v[220:223], v[44:47], v[100:103]
    v_cvt_pk_bf16_f32 v8, v88, v89
    v_lshlrev_b32 v88, 16, v8
    v_and_b32 v89, s90, v8
    v_mul_f32 v88, s91, v88
    v_mul_f32 v89, s91, v89
    v_cvt_pk_bf16_f32 v8, v88, v89
    v_lshlrev_b32 v88, 16, v8
    v_and_b32 v89, s90, v8
    v_max3_f32 v25, v88, v89, v25
    v_cvt_pk_bf16_f32 v9, v90, v91
    v_lshlrev_b32 v90, 16, v9
    v_and_b32 v91, s90, v9
    v_mul_f32 v90, s91, v90
    v_mul_f32 v91, s91, v91
    v_cvt_pk_bf16_f32 v9, v90, v91
    v_lshlrev_b32 v90, 16, v9
    v_and_b32 v91, s90, v9
    v_max3_f32 v25, v90, v91, v25
    v_cvt_pk_bf16_f32 v8, v92, v93
    v_lshlrev_b32 v92, 16, v8
    v_and_b32 v93, s90, v8
    v_mul_f32 v92, s91, v92
    v_mul_f32 v93, s91, v93
    v_cvt_pk_bf16_f32 v8, v92, v93
    v_lshlrev_b32 v92, 16, v8
    v_and_b32 v93, s90, v8
    v_max3_f32 v25, v92, v93, v25
    v_cvt_pk_bf16_f32 v9, v94, v95
    v_lshlrev_b32 v94, 16, v9
    v_and_b32 v95, s90, v9
    v_mul_f32 v94, s91, v94
    v_mul_f32 v95, s91, v95
    v_cvt_pk_bf16_f32 v9, v94, v95
    v_lshlrev_b32 v94, 16, v9
    v_and_b32 v95, s90, v9
    v_max3_f32 v25, v94, v95, v25
    v_mfma_f32_16x16x32_bf16 v[104:107], v[224:227], v[32:35], 0
    v_mfma_f32_16x16x32_bf16 v[108:111], v[240:243], v[32:35], 0
    v_mfma_f32_16x16x32_bf16 v[104:107], v[228:231], v[36:39], v[104:107]
    v_mfma_f32_16x16x32_bf16 v[108:111], v[244:247], v[36:39], v[108:111]
    v_mfma_f32_16x16x32_bf16 v[104:107], v[232:235], v[40:43], v[104:107]
    v_mfma_f32_16x16x32_bf16 v[108:111], v[248:251], v[40:43], v[108:111]
    v_mfma_f32_16x16x32_bf16 v[104:107], v[236:239], v[44:47], v[104:107]
    v_mfma_f32_16x16x32_bf16 v[108:111], v[252:255], v[44:47], v[108:111]
    v_cvt_pk_bf16_f32 v8, v96, v97
    v_lshlrev_b32 v96, 16, v8
    v_and_b32 v97, s90, v8
    v_mul_f32 v96, s91, v96
    v_mul_f32 v97, s91, v97
    v_cvt_pk_bf16_f32 v8, v96, v97
    v_lshlrev_b32 v96, 16, v8
    v_and_b32 v97, s90, v8
    v_max3_f32 v25, v96, v97, v25
    v_cvt_pk_bf16_f32 v9, v98, v99
    v_lshlrev_b32 v98, 16, v9
    v_and_b32 v99, s90, v9
    v_mul_f32 v98, s91, v98
    v_mul_f32 v99, s91, v99
    v_cvt_pk_bf16_f32 v9, v98, v99
    v_lshlrev_b32 v98, 16, v9
    v_and_b32 v99, s90, v9
    v_max3_f32 v25, v98, v99, v25
    v_cvt_pk_bf16_f32 v8, v100, v101
    v_lshlrev_b32 v100, 16, v8
    v_and_b32 v101, s90, v8
    v_mul_f32 v100, s91, v100
    v_mul_f32 v101, s91, v101
    v_cvt_pk_bf16_f32 v8, v100, v101
    v_lshlrev_b32 v100, 16, v8
    v_and_b32 v101, s90, v8
    v_max3_f32 v25, v100, v101, v25
    v_cvt_pk_bf16_f32 v9, v102, v103
    v_lshlrev_b32 v102, 16, v9
    v_and_b32 v103, s90, v9
    v_mul_f32 v102, s91, v102
    v_mul_f32 v103, s91, v103
    v_cvt_pk_bf16_f32 v9, v102, v103
    v_lshlrev_b32 v102, 16, v9
    v_and_b32 v103, s90, v9
    v_max3_f32 v25, v102, v103, v25
    v_lshl_add_u32 v10, v2, 2, v3
    v_and_b32 v11, 7, v10
    v_lshlrev_b32 v11, 1, v11
    v_lshrrev_b32 v12, 1, v4
    v_xor_b32 v11, v11, v12
    v_lshlrev_b32 v10, 8, v10
    v_lshl_add_u32 v10, v11, 4, v10
    v_and_b32 v12, 1, v0
    v_lshl_add_u32 v10, v12, 3, v10
    s_lshl_b32 s6, s3, 13
    v_add_u32 v17, s6, v10
    v_xor_b32 v18, 32, v17
    v_xor_b32 v19, 64, v17
    v_xor_b32 v20, 96, v17
    v_xor_b32 v21, 128, v17
    v_xor_b32 v22, 160, v17
    v_xor_b32 v23, 192, v17
    v_xor_b32 v24, 224, v17
    v_cvt_pk_bf16_f32 v8, v104, v105
    v_lshlrev_b32 v104, 16, v8
    v_and_b32 v105, s90, v8
    v_mul_f32 v104, s91, v104
    v_mul_f32 v105, s91, v105
    v_cvt_pk_bf16_f32 v8, v104, v105
    v_lshlrev_b32 v104, 16, v8
    v_and_b32 v105, s90, v8
    v_max3_f32 v25, v104, v105, v25
    v_cvt_pk_bf16_f32 v9, v106, v107
    v_lshlrev_b32 v106, 16, v9
    v_and_b32 v107, s90, v9
    v_mul_f32 v106, s91, v106
    v_mul_f32 v107, s91, v107
    v_cvt_pk_bf16_f32 v9, v106, v107
    v_lshlrev_b32 v106, 16, v9
    v_and_b32 v107, s90, v9
    v_max3_f32 v25, v106, v107, v25
    v_cvt_pk_bf16_f32 v8, v108, v109
    v_lshlrev_b32 v108, 16, v8
    v_and_b32 v109, s90, v8
    v_mul_f32 v108, s91, v108
    v_mul_f32 v109, s91, v109
    v_cvt_pk_bf16_f32 v8, v108, v109
    v_lshlrev_b32 v108, 16, v8
    v_and_b32 v109, s90, v8
    v_max3_f32 v25, v108, v109, v25
    v_cvt_pk_bf16_f32 v9, v110, v111
    v_lshlrev_b32 v110, 16, v9
    v_and_b32 v111, s90, v9
    v_mul_f32 v110, s91, v110
    v_mul_f32 v111, s91, v111
    v_cvt_pk_bf16_f32 v9, v110, v111
    v_lshlrev_b32 v110, 16, v9
    v_and_b32 v111, s90, v9
    v_max3_f32 v25, v110, v111, v25
    v_mov_b32 v8, v25
    s_nop 1
    v_permlane32_swap_b32 v25, v8
    v_max_f32 v25, v25, v8
    v_mov_b32 v8, v25
    s_nop 1
    v_permlane16_swap_b32 v25, v8
    v_max_f32 v25, v25, v8
    v_mul_f32 v25, s92, v25
    v_lshlrev_b32 v9, 4, v2
    ds_bpermute_b32 v27, v9, v25
    v_fma_f32 v48, v48, s92, -v25
    v_fma_f32 v49, v49, s92, -v25
    v_exp_f32 v48, v48
    v_exp_f32 v49, v49
    v_fma_f32 v50, v50, s92, -v25
    v_fma_f32 v51, v51, s92, -v25
    v_exp_f32 v50, v50
    v_exp_f32 v51, v51
    v_add_f32 v26, v48, v49
    v_cvt_pk_bf16_f32 v128, v48, v49
    v_fma_f32 v52, v52, s92, -v25
    v_fma_f32 v53, v53, s92, -v25
    v_exp_f32 v52, v52
    v_exp_f32 v53, v53
    v_add_f32 v26, v26, v50
    v_add_f32 v26, v26, v51
    v_cvt_pk_bf16_f32 v129, v50, v51
    v_fma_f32 v54, v54, s92, -v25
    v_fma_f32 v55, v55, s92, -v25
    v_exp_f32 v54, v54
    v_exp_f32 v55, v55
    v_add_f32 v26, v26, v52
    v_add_f32 v26, v26, v53
    v_cvt_pk_bf16_f32 v130, v52, v53
    v_fma_f32 v56, v56, s92, -v25
    v_fma_f32 v57, v57, s92, -v25
    v_exp_f32 v56, v56
    v_exp_f32 v57, v57
    v_add_f32 v26, v26, v54
    v_add_f32 v26, v26, v55
    v_cvt_pk_bf16_f32 v131, v54, v55
    v_fma_f32 v58, v58, s92, -v25
    v_fma_f32 v59, v59, s92, -v25
    v_exp_f32 v58, v58
    v_exp_f32 v59, v59
    v_add_f32 v26, v26, v56
    v_add_f32 v26, v26, v57
    v_cvt_pk_bf16_f32 v132, v56, v57
    v_fma_f32 v60, v60, s92, -v25
    v_fma_f32 v61, v61, s92, -v25
    v_exp_f32 v60, v60
    v_exp_f32 v61, v61
    v_add_f32 v26, v26, v58
    v_add_f32 v26, v26, v59
    v_cvt_pk_bf16_f32 v133, v58, v59
    v_fma_f32 v62, v62, s92, -v25
    v_fma_f32 v63, v63, s92, -v25
    v_exp_f32 v62, v62
    v_exp_f32 v63, v63
    v_add_f32 v26, v26, v60
    v_add_f32 v26, v26, v61
    v_cvt_pk_bf16_f32 v134, v60, v61
    v_fma_f32 v64, v64, s92, -v25
    v_fma_f32 v65, v65, s92, -v25
    v_exp_f32 v64, v64
    v_exp_f32 v65, v65
    v_add_f32 v26, v26, v62
    v_add_f32 v26, v26, v63
    v_cvt_pk_bf16_f32 v135, v62, v63
    v_fma_f32 v66, v66, s92, -v25
    v_fma_f32 v67, v67, s92, -v25
    v_exp_f32 v66, v66
    v_exp_f32 v67, v67
    v_add_f32 v26, v26, v64
    v_add_f32 v26, v26, v65
    v_cvt_pk_bf16_f32 v136, v64, v65
    v_fma_f32 v68, v68, s92, -v25
    v_fma_f32 v69, v69, s92, -v25
    v_exp_f32 v68, v68
    v_exp_f32 v69, v69
    v_add_f32 v26, v26, v66
    v_add_f32 v26, v26, v67
    v_cvt_pk_bf16_f32 v137, v66, v67
    v_fma_f32 v70, v70, s92, -v25
    v_fma_f32 v71, v71, s92, -v25
    v_exp_f32 v70, v70
    v_exp_f32 v71, v71
    v_add_f32 v26, v26, v68
    v_add_f32 v26, v26, v69
    v_cvt_pk_bf16_f32 v138, v68, v69
    v_fma_f32 v72, v72, s92, -v25
    v_fma_f32 v73, v73, s92, -v25
    v_exp_f32 v72, v72
    v_exp_f32 v73, v73
    v_add_f32 v26, v26, v70
    v_add_f32 v26, v26, v71
    v_cvt_pk_bf16_f32 v139, v70, v71
    v_fma_f32 v74, v74, s92, -v25
    v_fma_f32 v75, v75, s92, -v25
    v_exp_f32 v74, v74
    v_exp_f32 v75, v75
    v_add_f32 v26, v26, v72
    v_add_f32 v26, v26, v73
    v_cvt_pk_bf16_f32 v140, v72, v73
    v_fma_f32 v76, v76, s92, -v25
    v_fma_f32 v77, v77, s92, -v25
    v_exp_f32 v76, v76
    v_exp_f32 v77, v77
    v_add_f32 v26, v26, v74
    v_add_f32 v26, v26, v75
    v_cvt_pk_bf16_f32 v141, v74, v75
    v_fma_f32 v78, v78, s92, -v25
    v_fma_f32 v79, v79, s92, -v25
    v_exp_f32 v78, v78
    v_exp_f32 v79, v79
    v_add_f32 v26, v26, v76
    v_add_f32 v26, v26, v77
    v_cvt_pk_bf16_f32 v142, v76, v77
    v_fma_f32 v80, v80, s92, -v25
    v_fma_f32 v81, v81, s92, -v25
    v_exp_f32 v80, v80
    v_exp_f32 v81, v81
    v_add_f32 v26, v26, v78
    v_add_f32 v26, v26, v79
    v_cvt_pk_bf16_f32 v143, v78, v79
    v_fma_f32 v82, v82, s92, -v25
    v_fma_f32 v83, v83, s92, -v25
    v_exp_f32 v82, v82
    v_exp_f32 v83, v83
    v_add_f32 v26, v26, v80
    v_add_f32 v26, v26, v81
    v_cvt_pk_bf16_f32 v144, v80, v81
    v_fma_f32 v84, v84, s92, -v25
    v_fma_f32 v85, v85, s92, -v25
    v_exp_f32 v84, v84
    v_exp_f32 v85, v85
    v_add_f32 v26, v26, v82
    v_add_f32 v26, v26, v83
    v_cvt_pk_bf16_f32 v145, v82, v83
    v_fma_f32 v86, v86, s92, -v25
    v_fma_f32 v87, v87, s92, -v25
    v_exp_f32 v86, v86
    v_exp_f32 v87, v87
    v_add_f32 v26, v26, v84
    v_add_f32 v26, v26, v85
    v_cvt_pk_bf16_f32 v146, v84, v85
    v_fma_f32 v88, v88, s92, -v25
    v_fma_f32 v89, v89, s92, -v25
    v_exp_f32 v88, v88
    v_exp_f32 v89, v89
    v_add_f32 v26, v26, v86
    v_add_f32 v26, v26, v87
    v_cvt_pk_bf16_f32 v147, v86, v87
    v_fma_f32 v90, v90, s92, -v25
    v_fma_f32 v91, v91, s92, -v25
    v_exp_f32 v90, v90
    v_exp_f32 v91, v91
    v_add_f32 v26, v26, v88
    v_add_f32 v26, v26, v89
    v_cvt_pk_bf16_f32 v148, v88, v89
    v_fma_f32 v92, v92, s92, -v25
    v_fma_f32 v93, v93, s92, -v25
    v_exp_f32 v92, v92
    v_exp_f32 v93, v93
    v_add_f32 v26, v26, v90
    v_add_f32 v26, v26, v91
    v_cvt_pk_bf16_f32 v149, v90, v91
    v_fma_f32 v94, v94, s92, -v25
    v_fma_f32 v95, v95, s92, -v25
    v_exp_f32 v94, v94
    v_exp_f32 v95, v95
    v_add_f32 v26, v26, v92
    v_add_f32 v26, v26, v93
    v_cvt_pk_bf16_f32 v150, v92, v93
    v_fma_f32 v96, v96, s92, -v25
    v_fma_f32 v97, v97, s92, -v25
    v_exp_f32 v96, v96
    v_exp_f32 v97, v97
    v_add_f32 v26, v26, v94
    v_add_f32 v26, v26, v95
    v_cvt_pk_bf16_f32 v151, v94, v95
    v_fma_f32 v98, v98, s92, -v25
    v_fma_f32 v99, v99, s92, -v25
    v_exp_f32 v98, v98
    v_exp_f32 v99, v99
    v_add_f32 v26, v26, v96
    v_add_f32 v26, v26, v97
    v_cvt_pk_bf16_f32 v152, v96, v97
    v_fma_f32 v100, v100, s92, -v25
    v_fma_f32 v101, v101, s92, -v25
    v_exp_f32 v100, v100
    v_exp_f32 v101, v101
    v_add_f32 v26, v26, v98
    v_add_f32 v26, v26, v99
    v_cvt_pk_bf16_f32 v153, v98, v99
    v_fma_f32 v102, v102, s92, -v25
    v_fma_f32 v103, v103, s92, -v25
    v_exp_f32 v102, v102
    v_exp_f32 v103, v103
    v_add_f32 v26, v26, v100
    v_add_f32 v26, v26, v101
    v_cvt_pk_bf16_f32 v154, v100, v101
    v_fma_f32 v104, v104, s92, -v25
    v_fma_f32 v105, v105, s92, -v25
    v_exp_f32 v104, v104
    v_exp_f32 v105, v105
    v_add_f32 v26, v26, v102
    v_add_f32 v26, v26, v103
    v_cvt_pk_bf16_f32 v155, v102, v103
    v_fma_f32 v106, v106, s92, -v25
    v_fma_f32 v107, v107, s92, -v25
    v_exp_f32 v106, v106
    v_exp_f32 v107, v107
    v_add_f32 v26, v26, v104
    v_add_f32 v26, v26, v105
    v_cvt_pk_bf16_f32 v156, v104, v105
    v_fma_f32 v108, v108, s92, -v25
    v_fma_f32 v109, v109, s92, -v25
    v_exp_f32 v108, v108
    v_exp_f32 v109, v109
    v_add_f32 v26, v26, v106
    v_add_f32 v26, v26, v107
    v_cvt_pk_bf16_f32 v157, v106, v107
    v_fma_f32 v110, v110, s92, -v25
    v_fma_f32 v111, v111, s92, -v25
    v_exp_f32 v110, v110
    v_exp_f32 v111, v111
    v_add_f32 v26, v26, v108
    v_add_f32 v26, v26, v109
    v_cvt_pk_bf16_f32 v158, v108, v109
    v_add_f32 v26, v26, v110
    v_add_f32 v26, v26, v111
    v_cvt_pk_bf16_f32 v159, v110, v111
    v_mov_b32 v8, v26
    s_nop 1
    v_permlane32_swap_b32 v26, v8
    v_add_f32 v26, v26, v8
    v_mov_b32 v8, v26
    s_nop 1
    v_permlane16_swap_b32 v26, v8
    v_add_f32 v26, v26, v8
    s_lshl_b32 s6, s3, 5
    s_add_u32 s6, s6, 131072
    v_lshlrev_b32 v8, 3, v3
    v_add_u32 v8, s6, v8
    v_mov_b32 v10, v25
    v_mov_b32 v11, v26
    s_mov_b64 exec, 0x1111
    ds_write_b64 v8, v[10:11] offset:29920
    s_mov_b64 exec, -1
    s_lshl_b32 s6, s3, 10
    s_add_u32 s6, s6, 131072
    v_add_u32 v12, s6, v1
    ds_write_b128 v12, v[156:159] offset:24704
    s_waitcnt lgkmcnt(0)
    s_mov_b64 exec, 1
    ds_add_u32 v6, v7 offset:29884
    s_mov_b64 exec, -1
L_smdone:
    s_lshl_b32 s6, s3, 11
    s_add_u32 s6, s6, 147456
    v_lshlrev_b32 v29, 3, v0
    s_lshl_b32 s7, s3, 9
    s_add_u32 s7, s7, 147456
    v_add_u32 v106, s7, v29
    v_add_u32 v29, s6, v29
    s_lshl_b32 s6, s3, 13
    s_sub_u32 s6, 0x18000, s6
    s_lshl_b32 s7, s3, 6
    v_xor_b32 v104, s7, v17
    v_add_u32 v104, s6, v104
    v_xor_b32 v105, 32, v104
    v_lshrrev_b32 v8, 1, v5
    v_lshlrev_b32 v86, 14, v2
    v_lshl_add_u32 v86, v8, 4, v86
    s_lshl_b32 s6, s3, 7
    s_add_u32 s98, s98, s6
    v_mov_b32 v98, s4
    v_mov_b32 v99, s5
    s_add_u32 s96, s98, 0x180000
    s_getreg_b32 s70, hwreg(HW_REG_XCC_ID, 0, 4)
    s_add_u32 s70, s70, 1
    s_xor_b32 s70, s70, s4
    s_mov_b32 s71, s5
    v_and_b32 v8, 1, v3
    v_lshlrev_b32 v80, 11, v8
    v_lshl_add_u32 v80, v2, 8, v80
    v_lshrrev_b32 v8, 1, v3
    v_lshl_add_u32 v80, v8, 7, v80
    v_lshl_add_u32 v80, v4, 3, v80
    s_lshl_b32 s6, s3, 5
    s_add_u32 s6, s6, 131072
    v_add_u32 v80, s6, v80
    v_lshrrev_b32 v8, 1, v5
    v_lshlrev_b32 v85, 16, v8
    v_lshlrev_b32 v8, 10, v8
    v_and_b32 v10, 1, v0
    v_lshl_add_u32 v8, v10, 8, v8
    v_add_u32 v9, 0, v2
    v_xor_b32 v9, v9, v5
    v_lshl_add_u32 v81, v9, 4, v8
    v_add_u32 v9, 4, v2
    v_xor_b32 v9, v9, v5
    v_lshl_add_u32 v82, v9, 4, v8
    v_add_u32 v9, 8, v2
    v_xor_b32 v9, v9, v5
    v_lshl_add_u32 v83, v9, 4, v8
    v_add_u32 v9, 12, v2
    v_xor_b32 v9, v9, v5
    v_lshl_add_u32 v84, v9, 4, v8
    v_lshl_add_u32 v85, v2, 4, v85
    v_and_b32 v10, 1, v2
    v_cmp_eq_u32 vcc, 1, v10
    s_nop 1
    v_cndmask_b32 v87, v98, v99, vcc
    v_mov_b32 v98, s70
    s_lshr_b32 s97, s9, 3
    s_lshl2_add_u32 s97, s97, s3
    s_lshl_b32 s97, s97, 12
    s_add_u32 s97, s97, 0x200000
    v_lshrrev_b32 v10, 5, v0
    s_lshl_b32 s8, s3, 2
    v_add_u32 v11, s8, v10
    v_xor_b32 v11, v11, v5
    s_lshl_b32 s6, s3, 11
    v_lshlrev_b32 v10, 8, v10
    v_add_u32 v10, s6, v10
    v_and_b32 v12, 1, v2
    v_lshl_add_u32 v10, v12, 3, v10
    v_lshl_add_u32 v108, v11, 4, v10
    v_xor_b32 v109, 32, v108
    s_mov_b32 s52, 0x7060500
    s_mov_b32 s53, 0x7060501
    s_mov_b32 s54, 0x7060502
    s_mov_b32 s55, 0x7060503
    s_add_u32 s6, s3, 33
    s_cmp_ge_u32 s101, s6
    s_cbranch_scc1 L_lok_27
    s_mov_b32 s10, 0
L_lagain_28:
    ds_read_b32 v16, v6 offset:29824
    s_waitcnt lgkmcnt(0)
    v_readfirstlane_b32 s101, v16
    s_nop 0
    s_cmp_ge_u32 s101, s6
    s_cbranch_scc1 L_lok_27
    s_sleep 1
    s_add_u32 s10, s10, 1
    s_cmp_lt_u32 s10, 4194304
    s_cbranch_scc1 L_lagain_28
L_lok_27:
    ds_read_b64_tr_b16 v[160:161], v17 offset:0
    ds_read_b64_tr_b16 v[162:163], v17 offset:4096
    ds_read_b64_tr_b16 v[164:165], v18 offset:0
    ds_read_b64_tr_b16 v[166:167], v18 offset:4096
    ds_read_b64_tr_b16 v[168:169], v19 offset:0
    ds_read_b64_tr_b16 v[170:171], v19 offset:4096
    ds_read_b64_tr_b16 v[172:173], v20 offset:0
    ds_read_b64_tr_b16 v[174:175], v20 offset:4096
    ds_read_b64_tr_b16 v[176:177], v21 offset:0
    ds_read_b64_tr_b16 v[178:179], v21 offset:4096
    ds_read_b64_tr_b16 v[180:181], v22 offset:0
    ds_read_b64_tr_b16 v[182:183], v22 offset:4096
    ds_read_b64_tr_b16 v[184:185], v23 offset:0
    ds_read_b64_tr_b16 v[186:187], v23 offset:4096
    ds_read_b64_tr_b16 v[188:189], v24 offset:0
    ds_read_b64_tr_b16 v[190:191], v24 offset:4096
    s_waitcnt lgkmcnt(14)
    v_mfma_f32_16x16x32_bf16 v[48:51], v[128:131], v[160:163], 0
    s_waitcnt lgkmcnt(12)
    v_mfma_f32_16x16x32_bf16 v[52:55], v[128:131], v[164:167], 0
    s_waitcnt lgkmcnt(10)
    v_mfma_f32_16x16x32_bf16 v[56:59], v[128:131], v[168:171], 0
    s_waitcnt lgkmcnt(8)
    v_mfma_f32_16x16x32_bf16 v[60:63], v[128:131], v[172:175], 0
    s_waitcnt lgkmcnt(6)
    v_mfma_f32_16x16x32_bf16 v[64:67], v[128:131], v[176:179], 0
    s_waitcnt lgkmcnt(4)
    v_mfma_f32_16x16x32_bf16 v[68:71], v[128:131], v[180:183], 0
    s_waitcnt lgkmcnt(2)
    v_mfma_f32_16x16x32_bf16 v[72:75], v[128:131], v[184:187], 0
    s_waitcnt lgkmcnt(0)
    s_mov_b64 exec, 1
    ds_add_u32 v30, v31 offset:29840
    s_mov_b64 exec, -1
    v_mfma_f32_16x16x32_bf16 v[76:79], v[128:131], v[188:191], 0
    s_add_u32 s6, s3, 37
    s_cmp_ge_u32 s101, s6
    s_cbranch_scc1 L_lok_29
    s_mov_b32 s10, 0
L_lagain_30:
    ds_read_b32 v16, v6 offset:29824
    s_waitcnt lgkmcnt(0)
    v_readfirstlane_b32 s101, v16
    s_nop 0
    s_cmp_ge_u32 s101, s6
    s_cbranch_scc1 L_lok_29
    s_sleep 1
    s_add_u32 s10, s10, 1
    s_cmp_lt_u32 s10, 4194304
    s_cbranch_scc1 L_lagain_30
L_lok_29:
    ds_read_b64_tr_b16 v[192:193], v17 offset:32768
    ds_read_b64_tr_b16 v[194:195], v17 offset:36864
    ds_read_b64_tr_b16 v[196:197], v18 offset:32768
    ds_read_b64_tr_b16 v[198:199], v18 offset:36864
    ds_read_b64_tr_b16 v[200:201], v19 offset:32768
    ds_read_b64_tr_b16 v[202:203], v19 offset:36864
    ds_read_b64_tr_b16 v[204:205], v20 offset:32768
    ds_read_b64_tr_b16 v[206:207], v20 offset:36864
    ds_read_b64_tr_b16 v[208:209], v21 offset:32768
    ds_read_b64_tr_b16 v[210:211], v21 offset:36864
    ds_read_b64_tr_b16 v[212:213], v22 offset:32768
    ds_read_b64_tr_b16 v[214:215], v22 offset:36864
    ds_read_b64_tr_b16 v[216:217], v23 offset:32768
    ds_read_b64_tr_b16 v[218:219], v23 offset:36864
    ds_read_b64_tr_b16 v[220:221], v24 offset:32768
    ds_read_b64_tr_b16 v[222:223], v24 offset:36864
    v_add_u32 v17, 0x10000, v17
    v_add_u32 v18, 0x10000, v18
    v_add_u32 v19, 0x10000, v19
    v_add_u32 v20, 0x10000, v20
    v_add_u32 v21, 0x10000, v21
    v_add_u32 v22, 0x10000, v22
    v_add_u32 v23, 0x10000, v23
    v_add_u32 v24, 0x10000, v24
    s_waitcnt lgkmcnt(14)
    v_mfma_f32_16x16x32_bf16 v[48:51], v[132:135], v[192:195], v[48:51]
    s_waitcnt lgkmcnt(12)
    v_mfma_f32_16x16x32_bf16 v[52:55], v[132:135], v[196:199], v[52:55]
    s_waitcnt lgkmcnt(10)
    v_mfma_f32_16x16x32_bf16 v[56:59], v[132:135], v[200:203], v[56:59]
    s_waitcnt lgkmcnt(8)
    v_mfma_f32_16x16x32_bf16 v[60:63], v[132:135], v[204:207], v[60:63]
    s_waitcnt lgkmcnt(6)
    v_mfma_f32_16x16x32_bf16 v[64:67], v[132:135], v[208:211], v[64:67]
    s_waitcnt lgkmcnt(4)
    v_mfma_f32_16x16x32_bf16 v[68:71], v[132:135], v[212:215], v[68:71]
    s_waitcnt lgkmcnt(2)
    v_mfma_f32_16x16x32_bf16 v[72:75], v[132:135], v[216:219], v[72:75]
    s_waitcnt lgkmcnt(0)
    s_mov_b64 exec, 1
    ds_add_u32 v30, v31 offset:29840
    s_mov_b64 exec, -1
    v_mfma_f32_16x16x32_bf16 v[76:79], v[132:135], v[220:223], v[76:79]
    s_add_u32 s6, s3, 41
    s_cmp_ge_u32 s101, s6
    s_cbranch_scc1 L_lok_31
    s_mov_b32 s10, 0
L_lagain_32:
    ds_read_b32 v16, v6 offset:29824
    s_waitcnt lgkmcnt(0)
    v_readfirstlane_b32 s101, v16
    s_nop 0
    s_cmp_ge_u32 s101, s6
    s_cbranch_scc1 L_lok_31
    s_sleep 1
    s_add_u32 s10, s10, 1
    s_cmp_lt_u32 s10, 4194304
    s_cbranch_scc1 L_lagain_32
L_lok_31:
    ds_read_b64_tr_b16 v[160:161], v17 offset:0
    ds_read_b64_tr_b16 v[162:163], v17 offset:4096
    ds_read_b64_tr_b16 v[164:165], v18 offset:0
    ds_read_b64_tr_b16 v[166:167], v18 offset:4096
    ds_read_b64_tr_b16 v[168:169], v19 offset:0
    ds_read_b64_tr_b16 v[170:171], v19 offset:4096
    ds_read_b64_tr_b16 v[172:173], v20 offset:0
    ds_read_b64_tr_b16 v[174:175], v20 offset:4096
    ds_read_b64_tr_b16 v[176:177], v21 offset:0
    ds_read_b64_tr_b16 v[178:179], v21 offset:4096
    ds_read_b64_tr_b16 v[180:181], v22 offset:0
    ds_read_b64_tr_b16 v[182:183], v22 offset:4096
    ds_read_b64_tr_b16 v[184:185], v23 offset:0
    ds_read_b64_tr_b16 v[186:187], v23 offset:4096
    ds_read_b64_tr_b16 v[188:189], v24 offset:0
    ds_read_b64_tr_b16 v[190:191], v24 offset:4096
    s_waitcnt lgkmcnt(14)
    v_mfma_f32_16x16x32_bf16 v[48:51], v[136:139], v[160:163], v[48:51]
    s_waitcnt lgkmcnt(12)
    v_mfma_f32_16x16x32_bf16 v[52:55], v[136:139], v[164:167], v[52:55]
    s_waitcnt lgkmcnt(10)
    v_mfma_f32_16x16x32_bf16 v[56:59], v[136:139], v[168:171], v[56:59]
    s_waitcnt lgkmcnt(8)
    v_mfma_f32_16x16x32_bf16 v[60:63], v[136:139], v[172:175], v[60:63]
    s_waitcnt lgkmcnt(6)
    v_mfma_f32_16x16x32_bf16 v[64:67], v[136:139], v[176:179], v[64:67]
    s_waitcnt lgkmcnt(4)
    v_mfma_f32_16x16x32_bf16 v[68:71], v[136:139], v[180:183], v[68:71]
    s_waitcnt lgkmcnt(2)
    v_mfma_f32_16x16x32_bf16 v[72:75], v[136:139], v[184:187], v[72:75]
    s_waitcnt lgkmcnt(0)
    s_mov_b64 exec, 1
    ds_add_u32 v30, v31 offset:29840
    s_mov_b64 exec, -1
    v_mfma_f32_16x16x32_bf16 v[76:79], v[136:139], v[188:191], v[76:79]
    s_branch L_pv
.p2align 12
L_pv:
    s_add_u32 s6, s3, 45
    s_cmp_ge_u32 s101, s6
    s_cbranch_scc1 L_lok_33
    s_mov_b32 s10, 0
L_lagain_34:
    ds_read_b32 v16, v6 offset:29824
    s_waitcnt lgkmcnt(0)
    v_readfirstlane_b32 s101, v16
    s_nop 0
    s_cmp_ge_u32 s101, s6
    s_cbranch_scc1 L_lok_33
    s_sleep 1
    s_add_u32 s10, s10, 1
    s_cmp_lt_u32 s10, 4194304
    s_cbranch_scc1 L_lagain_34
L_lok_33:
    ds_read_b64_tr_b16 v[192:193], v17 offset:32768
    ds_read_b64_tr_b16 v[194:195], v17 offset:36864
    ds_read_b64_tr_b16 v[196:197], v18 offset:32768
    ds_read_b64_tr_b16 v[198:199], v18 offset:36864
    ds_read_b64_tr_b16 v[200:201], v19 offset:32768
    ds_read_b64_tr_b16 v[202:203], v19 offset:36864
    ds_read_b64_tr_b16 v[204:205], v20 offset:32768
    ds_read_b64_tr_b16 v[206:207], v20 offset:36864
    ds_read_b64_tr_b16 v[208:209], v21 offset:32768
    ds_read_b64_tr_b16 v[210:211], v21 offset:36864
    ds_read_b64_tr_b16 v[212:213], v22 offset:32768
    ds_read_b64_tr_b16 v[214:215], v22 offset:36864
    ds_read_b64_tr_b16 v[216:217], v23 offset:32768
    ds_read_b64_tr_b16 v[218:219], v23 offset:36864
    ds_read_b64_tr_b16 v[220:221], v24 offset:32768
    ds_read_b64_tr_b16 v[222:223], v24 offset:36864
    v_subrev_u32 v17, 0x10000, v17
    v_subrev_u32 v18, 0x10000, v18
    v_subrev_u32 v19, 0x10000, v19
    v_subrev_u32 v20, 0x10000, v20
    v_subrev_u32 v21, 0x10000, v21
    v_subrev_u32 v22, 0x10000, v22
    v_subrev_u32 v23, 0x10000, v23
    v_subrev_u32 v24, 0x10000, v24
    s_waitcnt lgkmcnt(14)
    v_mfma_f32_16x16x32_bf16 v[48:51], v[140:143], v[192:195], v[48:51]
    s_waitcnt lgkmcnt(12)
    v_mfma_f32_16x16x32_bf16 v[52:55], v[140:143], v[196:199], v[52:55]
    s_waitcnt lgkmcnt(10)
    v_mfma_f32_16x16x32_bf16 v[56:59], v[140:143], v[200:203], v[56:59]
    s_waitcnt lgkmcnt(8)
    v_mfma_f32_16x16x32_bf16 v[60:63], v[140:143], v[204:207], v[60:63]
    s_waitcnt lgkmcnt(6)
    v_mfma_f32_16x16x32_bf16 v[64:67], v[140:143], v[208:211], v[64:67]
    s_waitcnt lgkmcnt(4)
    v_mfma_f32_16x16x32_bf16 v[68:71], v[140:143], v[212:215], v[68:71]
    s_waitcnt lgkmcnt(2)
    v_mfma_f32_16x16x32_bf16 v[72:75], v[140:143], v[216:219], v[72:75]
    s_waitcnt lgkmcnt(0)
    s_mov_b64 exec, 1
    ds_add_u32 v30, v31 offset:29840
    s_mov_b64 exec, -1
    v_mfma_f32_16x16x32_bf16 v[76:79], v[140:143], v[220:223], v[76:79]
    s_add_u32 s6, s3, 49
    s_cmp_ge_u32 s101, s6
    s_cbranch_scc1 L_lok_35
    s_mov_b32 s10, 0
L_lagain_36:
    ds_read_b32 v16, v6 offset:29824
    s_waitcnt lgkmcnt(0)
    v_readfirstlane_b32 s101, v16
    s_nop 0
    s_cmp_ge_u32 s101, s6
    s_cbranch_scc1 L_lok_35
    s_sleep 1
    s_add_u32 s10, s10, 1
    s_cmp_lt_u32 s10, 4194304
    s_cbranch_scc1 L_lagain_36
L_lok_35:
    ds_read_b64_tr_b16 v[160:161], v17 offset:0
    ds_read_b64_tr_b16 v[162:163], v17 offset:4096
    ds_read_b64_tr_b16 v[164:165], v18 offset:0
    ds_read_b64_tr_b16 v[166:167], v18 offset:4096
    ds_read_b64_tr_b16 v[168:169], v19 offset:0
    ds_read_b64_tr_b16 v[170:171], v19 offset:4096
    ds_read_b64_tr_b16 v[172:173], v20 offset:0
    ds_read_b64_tr_b16 v[174:175], v20 offset:4096
    ds_read_b64_tr_b16 v[176:177], v21 offset:0
    ds_read_b64_tr_b16 v[178:179], v21 offset:4096
    ds_read_b64_tr_b16 v[180:181], v22 offset:0
    ds_read_b64_tr_b16 v[182:183], v22 offset:4096
    ds_read_b64_tr_b16 v[184:185], v23 offset:0
    ds_read_b64_tr_b16 v[186:187], v23 offset:4096
    ds_read_b64_tr_b16 v[188:189], v24 offset:0
    ds_read_b64_tr_b16 v[190:191], v24 offset:4096
    s_waitcnt lgkmcnt(14)
    v_mfma_f32_16x16x32_bf16 v[48:51], v[144:147], v[160:163], v[48:51]
    s_waitcnt lgkmcnt(12)
    v_mfma_f32_16x16x32_bf16 v[52:55], v[144:147], v[164:167], v[52:55]
    s_waitcnt lgkmcnt(10)
    v_mfma_f32_16x16x32_bf16 v[56:59], v[144:147], v[168:171], v[56:59]
    s_waitcnt lgkmcnt(8)
    v_mfma_f32_16x16x32_bf16 v[60:63], v[144:147], v[172:175], v[60:63]
    s_waitcnt lgkmcnt(6)
    v_mfma_f32_16x16x32_bf16 v[64:67], v[144:147], v[176:179], v[64:67]
    s_waitcnt lgkmcnt(4)
    v_mfma_f32_16x16x32_bf16 v[68:71], v[144:147], v[180:183], v[68:71]
    s_waitcnt lgkmcnt(2)
    v_mfma_f32_16x16x32_bf16 v[72:75], v[144:147], v[184:187], v[72:75]
    s_waitcnt lgkmcnt(0)
    v_mfma_f32_16x16x32_bf16 v[76:79], v[144:147], v[188:191], v[76:79]
    s_add_u32 s6, s3, 53
    s_cmp_ge_u32 s101, s6
    s_cbranch_scc1 L_lok_37
    s_mov_b32 s10, 0
L_lagain_38:
    ds_read_b32 v16, v6 offset:29824
    s_waitcnt lgkmcnt(0)
    v_readfirstlane_b32 s101, v16
    s_nop 0
    s_cmp_ge_u32 s101, s6
    s_cbranch_scc1 L_lok_37
    s_sleep 1
    s_add_u32 s10, s10, 1
    s_cmp_lt_u32 s10, 4194304
    s_cbranch_scc1 L_lagain_38
L_lok_37:
    ds_read_b64_tr_b16 v[192:193], v17 offset:32768
    ds_read_b64_tr_b16 v[194:195], v17 offset:36864
    ds_read_b64_tr_b16 v[196:197], v18 offset:32768
    ds_read_b64_tr_b16 v[198:199], v18 offset:36864
    ds_read_b64_tr_b16 v[200:201], v19 offset:32768
    ds_read_b64_tr_b16 v[202:203], v19 offset:36864
    ds_read_b64_tr_b16 v[204:205], v20 offset:32768
    ds_read_b64_tr_b16 v[206:207], v20 offset:36864
    ds_read_b64_tr_b16 v[208:209], v21 offset:32768
    ds_read_b64_tr_b16 v[210:211], v21 offset:36864
    ds_read_b64_tr_b16 v[212:213], v22 offset:32768
    ds_read_b64_tr_b16 v[214:215], v22 offset:36864
    ds_read_b64_tr_b16 v[216:217], v23 offset:32768
    ds_read_b64_tr_b16 v[218:219], v23 offset:36864
    ds_read_b64_tr_b16 v[220:221], v24 offset:32768
    ds_read_b64_tr_b16 v[222:223], v24 offset:36864
    v_add_u32 v17, 0x10000, v17
    v_add_u32 v18, 0x10000, v18
    v_add_u32 v19, 0x10000, v19
    v_add_u32 v20, 0x10000, v20
    v_add_u32 v21, 0x10000, v21
    v_add_u32 v22, 0x10000, v22
    v_add_u32 v23, 0x10000, v23
    v_add_u32 v24, 0x10000, v24
    s_waitcnt lgkmcnt(14)
    v_mfma_f32_16x16x32_bf16 v[48:51], v[148:151], v[192:195], v[48:51]
    s_waitcnt lgkmcnt(12)
    v_mfma_f32_16x16x32_bf16 v[52:55], v[148:151], v[196:199], v[52:55]
    s_waitcnt lgkmcnt(10)
    v_mfma_f32_16x16x32_bf16 v[56:59], v[148:151], v[200:203], v[56:59]
    s_waitcnt lgkmcnt(8)
    v_mfma_f32_16x16x32_bf16 v[60:63], v[148:151], v[204:207], v[60:63]
    s_waitcnt lgkmcnt(6)
    v_mfma_f32_16x16x32_bf16 v[64:67], v[148:151], v[208:211], v[64:67]
    s_waitcnt lgkmcnt(4)
    v_mfma_f32_16x16x32_bf16 v[68:71], v[148:151], v[212:215], v[68:71]
    s_waitcnt lgkmcnt(2)
    v_mfma_f32_16x16x32_bf16 v[72:75], v[148:151], v[216:219], v[72:75]
    s_waitcnt lgkmcnt(0)
    v_mfma_f32_16x16x32_bf16 v[76:79], v[148:151], v[220:223], v[76:79]
    s_mov_b32 s10, 0
L_lagain_40:
    ds_read_b32 v16, v6 offset:29888
    s_waitcnt lgkmcnt(0)
    v_readfirstlane_b32 s11, v16
    s_nop 0
    s_cmp_ge_u32 s11, 1
    s_cbranch_scc1 L_lok_39
    s_sleep 1
    s_add_u32 s10, s10, 1
    s_cmp_lt_u32 s10, 4194304
    s_cbranch_scc1 L_lagain_40
L_lok_39:
    v_lshl_add_u32 v8, v2, 3, v6
    ds_read_b64 v[10:11], v8 offset:30048
    ds_read_b32 v244, v8 offset:29920
    ds_read_b32 v245, v8 offset:29952
    ds_read_b32 v246, v8 offset:29984
    ds_read_b32 v247, v8 offset:30016
    v_add_u32 v9, v6, v1
    ds_read_b128 v[224:227], v9 offset:24704
    ds_read_b128 v[228:231], v9 offset:25728
    ds_read_b128 v[232:235], v9 offset:26752
    ds_read_b128 v[236:239], v9 offset:27776
    s_waitcnt lgkmcnt(4)
    v_sub_f32 v28, v27, v10
    v_sub_f32 v240, v244, v10
    v_sub_f32 v241, v245, v10
    v_sub_f32 v242, v246, v10
    v_sub_f32 v243, v247, v10
    v_exp_f32 v28, v28
    v_exp_f32 v240, v240
    v_exp_f32 v241, v241
    v_exp_f32 v242, v242
    v_exp_f32 v243, v243
    v_mul_f32 v28, v28, v11
    v_mul_f32 v240, v240, v11
    v_mul_f32 v241, v241, v11
    v_mul_f32 v242, v242, v11
    v_mul_f32 v243, v243, v11
    s_add_u32 s6, s3, 57
    s_cmp_ge_u32 s101, s6
    s_cbranch_scc1 L_lok_41
    s_mov_b32 s10, 0
L_lagain_42:
    ds_read_b32 v16, v6 offset:29824
    s_waitcnt lgkmcnt(0)
    v_readfirstlane_b32 s101, v16
    s_nop 0
    s_cmp_ge_u32 s101, s6
    s_cbranch_scc1 L_lok_41
    s_sleep 1
    s_add_u32 s10, s10, 1
    s_cmp_lt_u32 s10, 4194304
    s_cbranch_scc1 L_lagain_42
L_lok_41:
    ds_read_b64_tr_b16 v[160:161], v17 offset:0
    ds_read_b64_tr_b16 v[162:163], v17 offset:4096
    ds_read_b64_tr_b16 v[164:165], v18 offset:0
    ds_read_b64_tr_b16 v[166:167], v18 offset:4096
    ds_read_b64_tr_b16 v[168:169], v19 offset:0
    ds_read_b64_tr_b16 v[170:171], v19 offset:4096
    ds_read_b64_tr_b16 v[172:173], v20 offset:0
    ds_read_b64_tr_b16 v[174:175], v20 offset:4096
    ds_read_b64_tr_b16 v[176:177], v21 offset:0
    ds_read_b64_tr_b16 v[178:179], v21 offset:4096
    ds_read_b64_tr_b16 v[180:181], v22 offset:0
    ds_read_b64_tr_b16 v[182:183], v22 offset:4096
    ds_read_b64_tr_b16 v[184:185], v23 offset:0
    ds_read_b64_tr_b16 v[186:187], v23 offset:4096
    ds_read_b64_tr_b16 v[188:189], v24 offset:0
    ds_read_b64_tr_b16 v[190:191], v24 offset:4096
    s_waitcnt lgkmcnt(14)
    v_mfma_f32_16x16x32_bf16 v[48:51], v[152:155], v[160:163], v[48:51]
    s_waitcnt lgkmcnt(12)
    v_mfma_f32_16x16x32_bf16 v[52:55], v[152:155], v[164:167], v[52:55]
    s_waitcnt lgkmcnt(10)
    v_mfma_f32_16x16x32_bf16 v[56:59], v[152:155], v[168:171], v[56:59]
    s_waitcnt lgkmcnt(8)
    v_mfma_f32_16x16x32_bf16 v[60:63], v[152:155], v[172:175], v[60:63]
    s_waitcnt lgkmcnt(6)
    v_mfma_f32_16x16x32_bf16 v[64:67], v[152:155], v[176:179], v[64:67]
    s_waitcnt lgkmcnt(4)
    v_mfma_f32_16x16x32_bf16 v[68:71], v[152:155], v[180:183], v[68:71]
    s_waitcnt lgkmcnt(2)
    v_mfma_f32_16x16x32_bf16 v[72:75], v[152:155], v[184:187], v[72:75]
    s_waitcnt lgkmcnt(0)
    v_mfma_f32_16x16x32_bf16 v[76:79], v[152:155], v[188:191], v[76:79]
    v_mul_f32 v88, v28, v48
    v_mul_f32 v89, v28, v52
    v_mul_f32 v90, v28, v56
    v_mul_f32 v91, v28, v60
    v_mul_f32 v92, v28, v64
    v_mul_f32 v93, v28, v68
    v_mul_f32 v94, v28, v72
    s_nop 0
    v_mul_f32 v95, v28, v76
    ds_write2st64_b64 v29, v[88:89], v[90:91] offset0:0 offset1:1
    ds_write2st64_b64 v29, v[92:93], v[94:95] offset0:2 offset1:3
    s_waitcnt lgkmcnt(0)
    s_mov_b64 exec, 1
    ds_add_u32 v6, v7 offset:29896
    s_mov_b64 exec, -1
L_last:
    s_mov_b32 s10, 0
L_lagain_44:
    ds_read_b32 v16, v6 offset:29896
    s_waitcnt lgkmcnt(0)
    v_readfirstlane_b32 s11, v16
    s_nop 0
    s_cmp_ge_u32 s11, 4
    s_cbranch_scc1 L_lok_43
    s_add_u32 s10, s10, 1
    s_cmp_lt_u32 s10, 4194304
    s_cbranch_scc1 L_lagain_44
L_lok_43:
    ds_read2st64_b64 v[248:251], v106 offset0:0 offset1:4
    ds_read2st64_b64 v[252:255], v106 offset0:8 offset1:12
    s_cmp_ge_u32 s101, 61
    s_cbranch_scc1 L_lok_45
    s_mov_b32 s10, 0
L_lagain_46:
    ds_read_b32 v16, v6 offset:29824
    s_waitcnt lgkmcnt(0)
    v_readfirstlane_b32 s101, v16
    s_nop 0
    s_cmp_ge_u32 s101, 61
    s_cbranch_scc1 L_lok_45
    s_add_u32 s10, s10, 1
    s_cmp_lt_u32 s10, 4194304
    s_cbranch_scc1 L_lagain_46
L_lok_45:
    ds_read_b64_tr_b16 v[192:193], v104 offset:0
    ds_read_b64_tr_b16 v[194:195], v104 offset:4096
    ds_read_b64_tr_b16 v[196:197], v105 offset:0
    ds_read_b64_tr_b16 v[198:199], v105 offset:4096
    s_cmp_ge_u32 s101, 62
    s_cbranch_scc1 L_lok_47
    s_mov_b32 s10, 0
L_lagain_48:
    ds_read_b32 v16, v6 offset:29824
    s_waitcnt lgkmcnt(0)
    v_readfirstlane_b32 s101, v16
    s_nop 0
    s_cmp_ge_u32 s101, 62
    s_cbranch_scc1 L_lok_47
    s_add_u32 s10, s10, 1
    s_cmp_lt_u32 s10, 4194304
    s_cbranch_scc1 L_lagain_48
L_lok_47:
    ds_read_b64_tr_b16 v[200:201], v104 offset:8192
    ds_read_b64_tr_b16 v[202:203], v104 offset:12288
    ds_read_b64_tr_b16 v[204:205], v105 offset:8192
    ds_read_b64_tr_b16 v[206:207], v105 offset:12288
    s_cmp_ge_u32 s101, 63
    s_cbranch_scc1 L_lok_49
    s_mov_b32 s10, 0
L_lagain_50:
    ds_read_b32 v16, v6 offset:29824
    s_waitcnt lgkmcnt(0)
    v_readfirstlane_b32 s101, v16
    s_nop 0
    s_cmp_ge_u32 s101, 63
    s_cbranch_scc1 L_lok_49
    s_add_u32 s10, s10, 1
    s_cmp_lt_u32 s10, 4194304
    s_cbranch_scc1 L_lagain_50
L_lok_49:
    ds_read_b64_tr_b16 v[208:209], v104 offset:16384
    ds_read_b64_tr_b16 v[210:211], v104 offset:20480
    ds_read_b64_tr_b16 v[212:213], v105 offset:16384
    ds_read_b64_tr_b16 v[214:215], v105 offset:20480
    s_waitcnt lgkmcnt(10)
    ds_read_b32 v16, v6 offset:29824
    ds_read_b64_tr_b16 v[216:217], v104 offset:24576
    ds_read_b64_tr_b16 v[218:219], v104 offset:28672
    ds_read_b64_tr_b16 v[220:221], v105 offset:24576
    ds_read_b64_tr_b16 v[222:223], v105 offset:28672
    s_mov_b32 s10, 0
    s_waitcnt lgkmcnt(13)
    v_mfma_f32_16x16x32_bf16 v[48:51], v[224:227], v[192:195], 0
    v_mfma_f32_16x16x32_bf16 v[52:55], v[224:227], v[196:199], 0
    s_waitcnt lgkmcnt(9)
    v_mfma_f32_16x16x32_bf16 v[56:59], v[228:231], v[200:203], 0
    v_mfma_f32_16x16x32_bf16 v[60:63], v[228:231], v[204:207], 0
    s_waitcnt lgkmcnt(5)
    v_mfma_f32_16x16x32_bf16 v[64:67], v[232:235], v[208:211], 0
    v_mfma_f32_16x16x32_bf16 v[68:71], v[232:235], v[212:215], 0
    s_waitcnt lgkmcnt(4)
    v_readfirstlane_b32 s11, v16
    v_add_f32 v88, v248, v250
    v_add_f32 v252, v252, v254
    v_add_f32 v89, v249, v251
    v_add_f32 v253, v253, v255
    v_add_f32 v88, v88, v252
    v_add_f32 v89, v89, v253
    v_fmac_f32 v88, v240, v48
    v_fmac_f32 v89, v240, v52
    v_fmac_f32 v88, v241, v56
    v_fmac_f32 v89, v241, v60
    v_fmac_f32 v88, v242, v64
    v_fmac_f32 v89, v242, v68
    s_cmp_ge_u32 s11, 64
    s_cbranch_scc1 L_lastok
L_lastw:
    ds_read_b32 v16, v6 offset:29824
    ds_read_b64_tr_b16 v[216:217], v104 offset:24576
    ds_read_b64_tr_b16 v[218:219], v104 offset:28672
    ds_read_b64_tr_b16 v[220:221], v105 offset:24576
    ds_read_b64_tr_b16 v[222:223], v105 offset:28672
    s_add_u32 s10, s10, 1
    s_cmp_ge_u32 s10, 4194304
    s_cselect_b32 s6, 0, 64
    s_waitcnt lgkmcnt(4)
    v_readfirstlane_b32 s11, v16
    s_nop 0
    s_cmp_lt_u32 s11, s6
    s_cbranch_scc1 L_lastw
L_lastok:
    s_waitcnt lgkmcnt(2)
    v_mfma_f32_16x16x32_bf16 v[72:75], v[236:239], v[216:219], 0
    s_waitcnt lgkmcnt(0)
    v_mfma_f32_16x16x32_bf16 v[76:79], v[236:239], v[220:223], 0
    s_nop 5
    v_fmac_f32 v88, v243, v72
    s_nop 0
    v_fmac_f32 v89, v243, v76
    v_cvt_pk_bf16_f32 v96, v88, v89
    s_nop 1
    v_mov_b32_dpp v97, v96 quad_perm:[1,0,3,2] row_mask:0xf bank_mask:0xf
    s_mov_b32 exec_lo, 0x55555555
    s_mov_b32 exec_hi, 0x55555555
    buffer_store_dwordx4 v[96:99], v86, s[84:87], s96 offen
    s_mov_b64 exec, -1
L_published:
    s_cmp_gt_u32 s3, 1
    s_cbranch_scc1 L_nogather
    buffer_load_dwordx4 v[32:35], v1, s[84:87], s97 offen offset:0 nt
    buffer_load_dwordx4 v[36:39], v1, s[84:87], s97 offen offset:1024 nt
    buffer_load_dwordx4 v[40:43], v1, s[84:87], s97 offen offset:2048 nt
    buffer_load_dwordx4 v[44:47], v1, s[84:87], s97 offen offset:3072 nt
    s_mov_b32 s10, 0
L_lagain_52:
    ds_read_b32 v16, v6 offset:29892
    s_waitcnt lgkmcnt(0)
    v_readfirstlane_b32 s11, v16
    s_nop 0
    s_cmp_ge_u32 s11, 1
    s_cbranch_scc1 L_lok_51
    s_add_u32 s10, s10, 1
    s_cmp_lt_u32 s10, 4194304
    s_cbranch_scc1 L_lagain_52
L_lok_51:
    ds_read_b64_tr_b16 v[128:129], v80 offset:0
    ds_read_b64_tr_b16 v[130:131], v80 offset:8192
    ds_read_b64_tr_b16 v[132:133], v80 offset:1024
    ds_read_b64_tr_b16 v[134:135], v80 offset:9216
    ds_read_b64_tr_b16 v[136:137], v80 offset:4096
    ds_read_b64_tr_b16 v[138:139], v80 offset:12288
    ds_read_b64_tr_b16 v[140:141], v80 offset:5120
    ds_read_b64_tr_b16 v[142:143], v80 offset:13312
    s_mov_b32 s10, 0
    s_branch L_check_56
L_near_55:
    s_waitcnt lgkmcnt(0)
    s_mov_b64 exec, vcc
    buffer_load_dwordx4 v[32:35], v1, s[84:87], s97 offen offset:0 nt
    s_mov_b64 exec, s[12:13]
    buffer_load_dwordx4 v[36:39], v1, s[84:87], s97 offen offset:1024 nt
    s_mov_b64 exec, s[88:89]
    buffer_load_dwordx4 v[40:43], v1, s[84:87], s97 offen offset:2048 nt
    s_mov_b64 exec, s[82:83]
    buffer_load_dwordx4 v[44:47], v1, s[84:87], s97 offen offset:3072 nt
    s_mov_b64 exec, -1
    s_add_u32 s10, s10, 1
    s_cmp_ge_u32 s10, 32
    s_cbranch_scc1 L_cold_57
L_check_56:
    s_waitcnt vmcnt(0)
    ds_write_b64 v108, v[32:33] offset:0
    ds_write_b64 v108, v[36:37] offset:512
    ds_write_b64 v109, v[40:41] offset:1024
    ds_write_b64 v109, v[44:45] offset:1536
    v_cmp_ne_u64 vcc, s[70:71], v[34:35]
    v_cmp_ne_u64 s[12:13], s[70:71], v[38:39]
    v_cmp_ne_u64 s[88:89], s[70:71], v[42:43]
    v_cmp_ne_u64 s[82:83], s[70:71], v[46:47]
    s_or_b64 s[92:93], vcc, s[12:13]
    s_or_b64 s[94:95], s[88:89], s[82:83]
    s_or_b64 s[92:93], s[92:93], s[94:95]
    s_cbranch_scc1 L_near_55
L_ok_53:
    s_branch L_barE
L_nogather:
    s_mov_b32 s10, 0
L_lagain_59:
    ds_read_b32 v16, v6 offset:29892
    s_waitcnt lgkmcnt(0)
    v_readfirstlane_b32 s11, v16
    s_nop 0
    s_cmp_ge_u32 s11, 1
    s_cbranch_scc1 L_lok_58
    s_add_u32 s10, s10, 1
    s_cmp_lt_u32 s10, 4194304
    s_cbranch_scc1 L_lagain_59
L_lok_58:
    ds_read_b64_tr_b16 v[128:129], v80 offset:0
    ds_read_b64_tr_b16 v[130:131], v80 offset:8192
    ds_read_b64_tr_b16 v[132:133], v80 offset:1024
    ds_read_b64_tr_b16 v[134:135], v80 offset:9216
    ds_read_b64_tr_b16 v[136:137], v80 offset:4096
    ds_read_b64_tr_b16 v[138:139], v80 offset:12288
    ds_read_b64_tr_b16 v[140:141], v80 offset:5120
    ds_read_b64_tr_b16 v[142:143], v80 offset:13312
L_barE:
    s_waitcnt lgkmcnt(0)
    s_barrier
L_afterE:
    ds_read_b128 v[48:51], v81 offset:0
    ds_read_b128 v[52:55], v82 offset:0
    ds_read_b128 v[56:59], v83 offset:0
    ds_read_b128 v[60:63], v84 offset:0
    ds_read_b128 v[64:67], v81 offset:512
    ds_read_b128 v[68:71], v82 offset:512
    ds_read_b128 v[72:75], v83 offset:512
    ds_read_b128 v[76:79], v84 offset:512
    s_waitcnt lgkmcnt(7)
    v_mfma_f32_16x16x32_bf16 v[112:115], v[128:131], v[48:51], 0
    s_waitcnt lgkmcnt(6)
    v_mfma_f32_16x16x32_bf16 v[112:115], v[132:135], v[52:55], v[112:115]
    s_waitcnt lgkmcnt(5)
    v_mfma_f32_16x16x32_bf16 v[112:115], v[136:139], v[56:59], v[112:115]
    s_waitcnt lgkmcnt(4)
    v_mfma_f32_16x16x32_bf16 v[112:115], v[140:143], v[60:63], v[112:115]
    s_waitcnt lgkmcnt(3)
    v_mfma_f32_16x16x32_bf16 v[112:115], v[128:131], v[64:67], v[112:115]
    s_waitcnt lgkmcnt(2)
    v_mfma_f32_16x16x32_bf16 v[112:115], v[132:135], v[68:71], v[112:115]
    s_waitcnt lgkmcnt(1)
    v_mfma_f32_16x16x32_bf16 v[112:115], v[136:139], v[72:75], v[112:115]
    s_waitcnt lgkmcnt(0)
    v_mfma_f32_16x16x32_bf16 v[112:115], v[140:143], v[76:79], v[112:115]
    s_nop 7
    v_add_f32_dpp v112, v112, v112 quad_perm:[1,0,3,2] row_mask:0xf bank_mask:0xf
    v_add_f32_dpp v113, v113, v113 quad_perm:[1,0,3,2] row_mask:0xf bank_mask:0xf
    v_add_f32_dpp v114, v114, v114 quad_perm:[1,0,3,2] row_mask:0xf bank_mask:0xf
    v_add_f32_dpp v115, v115, v115 quad_perm:[1,0,3,2] row_mask:0xf bank_mask:0xf
    v_perm_b32 v112, v112, v87, s52
    v_perm_b32 v113, v113, v87, s53
    v_perm_b32 v114, v114, v87, s54
    v_perm_b32 v115, v115, v87, s55
    s_mov_b32 exec_lo, 0x55555555
    s_mov_b32 exec_hi, 0x55555555
    buffer_store_dwordx4 v[112:115], v85, s[84:87], s99 offen sc1
    s_branch L_done
.p2align 12
L_comm:
    v_mov_b32 v20, 0
    v_writelane_b32 v20, 12, 4
    v_writelane_b32 v20, 13, 5
    v_writelane_b32 v20, 14, 6
    v_writelane_b32 v20, 15, 7
    v_writelane_b32 v20, 20, 8
    v_writelane_b32 v20, 28, 9
    v_writelane_b32 v20, 28, 10
    v_writelane_b32 v20, 0, 11
    v_lshl_add_u32 v8, v0, 2, v6
    s_mov_b64 exec, 0xfffff
    ds_write_b32 v8, v20 offset:29824
    s_mov_b64 exec, -1
    s_waitcnt lgkmcnt(0)
    s_load_dwordx2 s[4:5], s[84:85], 0
    s_barrier
    s_lshr_b32 s6, s9, 2
    s_lshl_b32 s6, s6, 8
    s_add_u32 s100, s6, 0xc000
    v_lshlrev_b32 v28, 6, v0
    s_and_b32 s6, s9, 3
    s_lshl4_add_u32 s14, s6, s100
    v_add_u32 v8, v6, v1
    v_and_b32 v29, 7, v0
    v_lshlrev_b32 v29, 14, v29
    v_lshl_add_u32 v29, v2, 4, v29
    s_lshl_b32 s8, s15, 6
    s_add_u32 s8, s8, 0x20000
    s_bfe_u32 s6, s9, 0x30002
    s_lshl_b32 s6, s6, 14
    s_lshr_b32 s7, s9, 5
    s_lshl_b32 s7, s7, 11
    s_add_u32 s6, s6, s7
    s_add_u32 s6, s6, 0x20000
    v_lshl_add_u32 v27, v0, 3, v6
    s_waitcnt lgkmcnt(0)
    s_add_u32 s4, s4, 0x7f4a7c15
    s_addc_u32 s5, s5, 0x9e3779b9
    v_mov_b32 v38, s4
    v_mov_b32 v39, s5
    s_and_b32 s47, s4, 0xffff0000
    s_and_b32 s78, s2, 0x78
    s_and_b32 s79, s2, 7
    s_lshr_b32 s88, s2, 7
    s_lshl1_add_u32 s79, s79, s88
    s_lshl_b32 s79, s79, 6
    s_add_u32 s79, s79, 0x10000
    s_mov_b32 s48, 0
    s_mov_b32 s55, 1
    s_mov_b32 s81, 0
    s_mov_b32 s50, 0
    s_not_b32 s88, s47
    v_mov_b32 v113, s88
    v_mov_b32 v122, s88
    v_lshlrev_b32 v124, 2, v0
    v_lshlrev_b32 v125, 6, v0
    s_mov_b32 s53, 0
    v_mul_u32_u24 v31, 272, v2
    v_lshl_add_u32 v31, v5, 4, v31
    v_add_u32 v31, v6, v31
    v_lshlrev_b32 v29, 16, v2
    v_lshl_add_u32 v29, v5, 4, v29
    s_and_b32 s8, s15, 3
    s_lshr_b32 s6, s15, 5
    s_lshl2_add_u32 s6, s6, s8
    s_lshl_b32 s8, s6, 11
    s_bfe_u32 s6, s15, 0x30002
    s_lshl_b32 s6, s6, 8
    s_add_u32 s8, s8, s6
    s_add_u32 s8, s8, 0x280000
    s_mov_b32 s10, 0
L_lagain_61:
    ds_read_b32 v16, v6 offset:29876
    s_waitcnt lgkmcnt(0)
    v_readfirstlane_b32 s11, v16
    s_nop 0
    s_cmp_ge_u32 s11, 8
    s_cbranch_scc1 L_lok_60
    s_sleep 1
    s_add_u32 s10, s10, 1
    s_cmp_lt_u32 s10, 4194304
    s_cbranch_scc1 L_lagain_61
L_lok_60:
    ds_read_b128 v[40:43], v31 offset:24704
    ds_read_b128 v[44:47], v31 offset:25792
    s_waitcnt lgkmcnt(1)
    buffer_store_dwordx4 v[40:43], v29, s[84:87], s8 offen
    s_add_u32 s8, s8, 0x40000
    s_waitcnt lgkmcnt(0)
    buffer_store_dwordx4 v[44:47], v29, s[84:87], s8 offen
    s_add_u32 s8, s8, 0x40000
    s_bfe_u32 s6, s9, 0x30002
    s_lshl_b32 s6, s6, 16
    s_lshr_b32 s7, s9, 5
    s_lshl_b32 s7, s7, 13
    s_add_u32 s6, s6, s7
    s_add_u32 s6, s6, 0x280000
    s_add_u32 s7, s6, 4096
    v_and_b32 v30, 1, v0
    v_cmp_eq_u32 vcc, 1, v30
    s_nop 1
    v_cndmask_b32 v30, v38, v39, vcc
    s_mov_b32 s82, 0x0c0c0400
    s_mov_b32 s83, 0x04000c0c
    s_mov_b32 s45, 1
    s_mov_b32 s49, 8
    v_add_u32 v112, 29824, v6
    s_branch L_fast
L_ret1:
    s_mov_b32 s45, 2
    s_mov_b32 s49, -1
    buffer_load_dwordx4 v[48:51], v1, s[84:87], s6 offen offset:0 nt
    buffer_load_dwordx4 v[52:55], v1, s[84:87], s6 offen offset:1024 nt
    buffer_load_dwordx4 v[56:59], v1, s[84:87], s6 offen offset:2048 nt
    buffer_load_dwordx4 v[60:63], v1, s[84:87], s6 offen offset:3072 nt
    buffer_load_dwordx4 v[64:67], v1, s[84:87], s7 offen offset:0 nt
    buffer_load_dwordx4 v[68:71], v1, s[84:87], s7 offen offset:1024 nt
    buffer_load_dwordx4 v[72:75], v1, s[84:87], s7 offen offset:2048 nt
    buffer_load_dwordx4 v[76:79], v1, s[84:87], s7 offen offset:3072 nt
    s_mov_b32 s10, 0
L_q_near:
    s_waitcnt vmcnt(0)
    v_perm_b32 v80, v49, v48, s82
    v_perm_b32 v88, v51, v50, s83
    v_perm_b32 v81, v53, v52, s82
    v_perm_b32 v89, v55, v54, s83
    v_perm_b32 v82, v57, v56, s82
    v_perm_b32 v90, v59, v58, s83
    v_perm_b32 v83, v61, v60, s82
    v_perm_b32 v91, v63, v62, s83
    v_perm_b32 v84, v65, v64, s82
    v_perm_b32 v92, v67, v66, s83
    v_perm_b32 v85, v69, v68, s82
    v_perm_b32 v93, v71, v70, s83
    v_perm_b32 v86, v73, v72, s82
    v_perm_b32 v94, v75, v74, s83
    v_perm_b32 v87, v77, v76, s82
    v_perm_b32 v95, v79, v78, s83
    v_or_b32 v80, v80, v88
    v_or_b32 v81, v81, v89
    v_or_b32 v82, v82, v90
    v_or_b32 v83, v83, v91
    v_or_b32 v84, v84, v92
    v_or_b32 v85, v85, v93
    v_or_b32 v86, v86, v94
    v_or_b32 v87, v87, v95
    v_cmp_ne_u32 s[56:57], v30, v80
    v_cmp_ne_u32 s[58:59], v30, v81
    v_cmp_ne_u32 s[60:61], v30, v82
    v_cmp_ne_u32 s[62:63], v30, v83
    v_cmp_ne_u32 s[64:65], v30, v84
    v_cmp_ne_u32 s[66:67], v30, v85
    v_cmp_ne_u32 s[68:69], v30, v86
    v_cmp_ne_u32 s[70:71], v30, v87
    s_or_b64 s[92:93], s[56:57], s[58:59]
    s_or_b64 s[92:93], s[92:93], s[60:61]
    s_or_b64 s[92:93], s[92:93], s[62:63]
    s_or_b64 s[92:93], s[92:93], s[64:65]
    s_or_b64 s[92:93], s[92:93], s[66:67]
    s_or_b64 s[92:93], s[92:93], s[68:69]
    s_or_b64 s[92:93], s[92:93], s[70:71]
    s_cbranch_scc0 L_q_ok
    s_mov_b32 s55, 1
    s_branch L_fast
L_ret2:
    s_cmp_eq_u64 s[56:57], 0
    s_cbranch_scc1 L_q_62
    buffer_load_dwordx4 v[48:51], v1, s[84:87], s6 offen offset:0 nt
L_q_62:
    s_cmp_eq_u64 s[58:59], 0
    s_cbranch_scc1 L_q_63
    buffer_load_dwordx4 v[52:55], v1, s[84:87], s6 offen offset:1024 nt
L_q_63:
    s_cmp_eq_u64 s[60:61], 0
    s_cbranch_scc1 L_q_64
    buffer_load_dwordx4 v[56:59], v1, s[84:87], s6 offen offset:2048 nt
L_q_64:
    s_cmp_eq_u64 s[62:63], 0
    s_cbranch_scc1 L_q_65
    buffer_load_dwordx4 v[60:63], v1, s[84:87], s6 offen offset:3072 nt
L_q_65:
    s_cmp_eq_u64 s[64:65], 0
    s_cbranch_scc1 L_q_66
    buffer_load_dwordx4 v[64:67], v1, s[84:87], s7 offen offset:0 nt
L_q_66:
    s_cmp_eq_u64 s[66:67], 0
    s_cbranch_scc1 L_q_67
    buffer_load_dwordx4 v[68:71], v1, s[84:87], s7 offen offset:1024 nt
L_q_67:
    s_cmp_eq_u64 s[68:69], 0
    s_cbranch_scc1 L_q_68
    buffer_load_dwordx4 v[72:75], v1, s[84:87], s7 offen offset:2048 nt
L_q_68:
    s_cmp_eq_u64 s[70:71], 0
    s_cbranch_scc1 L_q_69
    buffer_load_dwordx4 v[76:79], v1, s[84:87], s7 offen offset:3072 nt
L_q_69:
    s_add_u32 s10, s10, 1
    s_cmp_lt_u32 s10, 24
    s_cbranch_scc1 L_q_near
    s_branch L_q_cold
    s_waitcnt vmcnt(0)
L_q_ok:
    v_add_f32 v48, v48, v56
    v_add_f32 v64, v64, v72
    v_add_f32 v49, v49, v57
    v_add_f32 v65, v65, v73
    v_add_f32 v50, v50, v58
    v_add_f32 v66, v66, v74
    v_add_f32 v51, v51, v59
    v_add_f32 v67, v67, v75
    v_add_f32 v52, v52, v60
    v_add_f32 v68, v68, v76
    v_add_f32 v53, v53, v61
    v_add_f32 v69, v69, v77
    v_add_f32 v54, v54, v62
    v_add_f32 v70, v70, v78
    v_add_f32 v55, v55, v63
    v_add_f32 v71, v71, v79
    v_add_f32 v48, v48, v64
    v_add_f32 v49, v49, v65
    v_add_f32 v50, v50, v66
    v_add_f32 v51, v51, v67
    v_add_f32 v52, v52, v68
    v_add_f32 v53, v53, v69
    v_add_f32 v54, v54, v70
    v_add_f32 v55, v55, v71
    v_cvt_pk_bf16_f32 v32, v48, v49
    v_cvt_pk_bf16_f32 v33, v50, v51
    v_cvt_pk_bf16_f32 v34, v52, v53
    v_cvt_pk_bf16_f32 v35, v54, v55
    ds_write_b64 v27, v[32:33] offset:28800
    ds_write_b64 v27, v[34:35] offset:29312
    s_waitcnt lgkmcnt(0)
    s_mov_b64 exec, 1
    ds_add_u32 v6, v7 offset:29880
    s_mov_b64 exec, -1
    s_mov_b32 s45, 0
    s_mov_b32 s49, 2
    v_add_u32 v112, 29900, v6
    s_branch L_fast
L_bal_back5:
    v_lshl_add_u32 v10, v5, 3, v6
    v_lshlrev_b32 v9, 4, v5
    s_mov_b32 s10, 0
L_lagain_71:
    ds_read_b32 v16, v6 offset:29884
    s_waitcnt lgkmcnt(0)
    v_readfirstlane_b32 s11, v16
    s_nop 0
    s_cmp_ge_u32 s11, 4
    s_cbranch_scc1 L_lok_70
    s_sleep 4
    s_add_u32 s10, s10, 1
    s_cmp_lt_u32 s10, 4194304
    s_cbranch_scc1 L_lagain_71
L_lok_70:
    s_mov_b32 s10, 0
L_lagain_73:
    ds_read_b32 v16, v6 offset:29872
    s_waitcnt lgkmcnt(0)
    v_readfirstlane_b32 s11, v16
    s_nop 0
    s_cmp_ge_u32 s11, 6
    s_cbranch_scc1 L_lok_72
    s_sleep 1
    s_add_u32 s10, s10, 1
    s_cmp_lt_u32 s10, 4194304
    s_cbranch_scc1 L_lagain_73
L_lok_72:
    ds_read_b64 v[32:33], v10 offset:29920
    s_waitcnt lgkmcnt(0)
    v_mov_b32 v36, v32
    s_nop 1
    v_max_f32_dpp v36, v36, v36 row_ror:4 row_mask:0xf bank_mask:0xf
    s_nop 1
    v_max_f32_dpp v36, v36, v36 row_ror:8 row_mask:0xf bank_mask:0xf
    v_sub_f32 v32, v32, v36
    v_exp_f32 v32, v32
    s_nop 0
    v_mul_f32 v37, v32, v33
    s_nop 1
    v_add_f32_dpp v37, v37, v37 row_ror:4 row_mask:0xf bank_mask:0xf
    s_nop 1
    v_add_f32_dpp v37, v37, v37 row_ror:8 row_mask:0xf bank_mask:0xf
    s_mov_b64 exec, 0xf
    buffer_store_dwordx4 v[36:39], v28, s[84:87], s14 offen
    s_mov_b64 exec, -1
    s_mov_b32 s10, 0
L_lagain_75:
    ds_read_b32 v16, v6 offset:29824
    s_waitcnt lgkmcnt(0)
    v_readfirstlane_b32 s11, v16
    s_nop 0
    s_cmp_ge_u32 s11, 48
    s_cbranch_scc1 L_lok_74
    s_sleep 8
    s_add_u32 s10, s10, 1
    s_cmp_lt_u32 s10, 4194304
    s_cbranch_scc1 L_lagain_75
L_lok_74:
    buffer_load_dwordx4 v[32:35], v9, s[84:87], s100 offen nt
    s_mov_b32 s10, 0
    s_branch L_check_79
L_near_78:
    s_sleep 8
    s_mov_b64 exec, vcc
    buffer_load_dwordx4 v[32:35], v9, s[84:87], s100 offen nt
    s_mov_b64 exec, -1
    s_add_u32 s10, s10, 1
    s_cmp_ge_u32 s10, 24
    s_cbranch_scc1 L_cold_80
L_check_79:
    s_waitcnt vmcnt(0)
    v_cmp_ne_u64 vcc, s[4:5], v[34:35]
    s_nop 0
    s_cmp_lg_u64 vcc, 0
    s_cbranch_scc1 L_near_78
L_ok_76:
    v_mov_b32 v36, v32
    s_nop 1
    v_max_f32_dpp v36, v36, v36 quad_perm:[1,0,3,2] row_mask:0xf bank_mask:0xf
    s_nop 1
    v_max_f32_dpp v36, v36, v36 quad_perm:[2,3,0,1] row_mask:0xf bank_mask:0xf
    v_sub_f32 v32, v32, v36
    v_exp_f32 v32, v32
    s_nop 0
    v_mul_f32 v37, v32, v33
    s_nop 1
    v_add_f32_dpp v37, v37, v37 quad_perm:[1,0,3,2] row_mask:0xf bank_mask:0xf
    s_nop 1
    v_add_f32_dpp v37, v37, v37 quad_perm:[2,3,0,1] row_mask:0xf bank_mask:0xf
    v_rcp_f32 v37, v37
    v_lshl_add_u32 v10, v3, 3, v6
    s_mov_b64 exec, 0x1111
    ds_write_b64 v10, v[36:37] offset:30048
    s_mov_b64 exec, -1
    s_waitcnt lgkmcnt(0)
    s_mov_b64 exec, 1
    ds_add_u32 v6, v7 offset:29888
    s_mov_b64 exec, -1
    s_mov_b32 s14, 2
L_gather56:
    s_getreg_b32 s70, hwreg(HW_REG_XCC_ID, 0, 4)
    s_add_u32 s70, s70, 1
    s_xor_b32 s70, s70, s4
    s_mov_b32 s71, s5
    s_lshr_b32 s7, s9, 3
    s_lshl2_add_u32 s7, s7, s14
    s_lshl_b32 s7, s7, 12
    s_add_u32 s7, s7, 0x200000
    s_mov_b32 s10, 0
L_lagain_82:
    ds_read_b32 v16, v6 offset:29824
    s_waitcnt lgkmcnt(0)
    v_readfirstlane_b32 s11, v16
    s_nop 0
    s_cmp_ge_u32 s11, 64
    s_cbranch_scc1 L_lok_81
    s_sleep 1
    s_add_u32 s10, s10, 1
    s_cmp_lt_u32 s10, 4194304
    s_cbranch_scc1 L_lagain_82
L_lok_81:
    buffer_load_dwordx4 v[32:35], v1, s[84:87], s7 offen offset:0 nt
    buffer_load_dwordx4 v[36:39], v1, s[84:87], s7 offen offset:1024 nt
    buffer_load_dwordx4 v[40:43], v1, s[84:87], s7 offen offset:2048 nt
    buffer_load_dwordx4 v[44:47], v1, s[84:87], s7 offen offset:3072 nt
    v_lshrrev_b32 v10, 5, v0
    s_lshl_b32 s8, s14, 2
    v_add_u32 v11, s8, v10
    v_xor_b32 v11, v11, v5
    s_lshl_b32 s6, s14, 11
    v_lshlrev_b32 v10, 8, v10
    v_add_u32 v10, s6, v10
    v_and_b32 v12, 1, v2
    v_lshl_add_u32 v10, v12, 3, v10
    v_lshl_add_u32 v13, v11, 4, v10
    v_xor_b32 v14, 32, v13
    s_mov_b32 s10, 0
L_lagain_84:
    ds_read_b32 v16, v6 offset:29896
    s_waitcnt lgkmcnt(0)
    v_readfirstlane_b32 s11, v16
    s_nop 0
    s_cmp_ge_u32 s11, 4
    s_cbranch_scc1 L_lok_83
    s_sleep 1
    s_add_u32 s10, s10, 1
    s_cmp_lt_u32 s10, 4194304
    s_cbranch_scc1 L_lagain_84
L_lok_83:
    s_mov_b32 s10, 0
    s_branch L_check_88
L_near_87:
    s_waitcnt lgkmcnt(0)
    s_mov_b64 exec, vcc
    buffer_load_dwordx4 v[32:35], v1, s[84:87], s7 offen offset:0 nt
    s_mov_b64 exec, s[12:13]
    buffer_load_dwordx4 v[36:39], v1, s[84:87], s7 offen offset:1024 nt
    s_mov_b64 exec, s[88:89]
    buffer_load_dwordx4 v[40:43], v1, s[84:87], s7 offen offset:2048 nt
    s_mov_b64 exec, s[82:83]
    buffer_load_dwordx4 v[44:47], v1, s[84:87], s7 offen offset:3072 nt
    s_mov_b64 exec, -1
    s_add_u32 s10, s10, 1
    s_cmp_ge_u32 s10, 32
    s_cbranch_scc1 L_cold_89
L_check_88:
    s_waitcnt vmcnt(0)
    ds_write_b64 v13, v[32:33] offset:0
    ds_write_b64 v13, v[36:37] offset:512
    ds_write_b64 v14, v[40:41] offset:1024
    ds_write_b64 v14, v[44:45] offset:1536
    v_cmp_ne_u64 vcc, s[70:71], v[34:35]
    v_cmp_ne_u64 s[12:13], s[70:71], v[38:39]
    v_cmp_ne_u64 s[88:89], s[70:71], v[42:43]
    v_cmp_ne_u64 s[82:83], s[70:71], v[46:47]
    s_or_b64 s[92:93], vcc, s[12:13]
    s_or_b64 s[94:95], s[88:89], s[82:83]
    s_or_b64 s[92:93], s[92:93], s[94:95]
    s_cbranch_scc1 L_near_87
L_ok_85:
    s_waitcnt lgkmcnt(0)
    s_barrier
    s_branch L_done
L_mlp:
    s_sub_u32 s15, s3, 6
    v_mul_u32_u24 v8, 12, v0
    s_mul_i32 s7, s15, 1792
    s_waitcnt lgkmcnt(0)
    s_load_dword s95, s[96:97], 0
    s_load_dwordx2 s[4:5], s[84:85], 0
    s_barrier
    buffer_load_dwordx4 v[32:35], v1, s[64:67], s7 offen
    buffer_load_dwordx3 v[36:38], v8, s[64:67], s7 offen offset:1024
    buffer_load_dwordx4 v[40:43], v1, s[68:71], s7 offen
    buffer_load_dwordx3 v[44:46], v8, s[68:71], s7 offen offset:1024
    buffer_load_dwordx4 v[48:51], v1, s[72:75], s7 offen
    buffer_load_dwordx3 v[52:54], v8, s[72:75], s7 offen offset:1024
    s_mov_b32 s93, 0xc0135761
    s_mov_b32 s94, 0xbdd2d3e8
    s_lshr_b32 s6, s9, 5
    s_mul_i32 s6, s6, 1040
    s_add_u32 s6, s6, 131072
    v_add_u32 v9, s6, v1
    s_and_b32 s6, s9, 31
    s_lshl_b32 s6, s6, 3
    v_bfe_u32 v11, v0, 3, 1
    v_lshl_add_u32 v11, v11, 2, s6
    s_mov_b32 s10, 0
L_lagain_91:
    ds_read_b32 v16, v6 offset:29872
    s_waitcnt lgkmcnt(0)
    v_readfirstlane_b32 s11, v16
    s_nop 0
    s_cmp_ge_u32 s11, 4
    s_cbranch_scc1 L_lok_90
    s_sleep 1
    s_add_u32 s10, s10, 1
    s_cmp_lt_u32 s10, 4194304
    s_cbranch_scc1 L_lagain_91
L_lok_90:
    s_add_u32 s4, s4, 0x7f4a7c15
    s_addc_u32 s5, s5, 0x9e3779b9
    ds_read_b128 v[112:115], v9 offset:16384
    s_waitcnt lgkmcnt(0)
    s_mov_b64 exec, 1
    ds_add_u32 v6, v7 offset:29872
    s_mov_b64 exec, -1
    v_lshlrev_b32 v116, 16, v112
    v_and_b32 v117, s90, v112
    v_lshlrev_b32 v118, 16, v113
    v_and_b32 v119, s90, v113
    v_lshlrev_b32 v120, 16, v114
    v_and_b32 v121, s90, v114
    v_lshlrev_b32 v122, 16, v115
    v_and_b32 v123, s90, v115
    v_add_f32 v132, v116, v117
    v_add_f32 v133, v118, v119
    v_add_f32 v132, v132, v120
    v_add_f32 v133, v133, v121
    v_add_f32 v132, v132, v122
    v_add_f32 v133, v133, v123
    v_add_f32 v132, v132, v133
    s_nop 1
    v_add_f32_dpp v132, v132, v132 quad_perm:[1,0,3,2] row_mask:0xf bank_mask:0xf
    s_nop 1
    v_add_f32_dpp v132, v132, v132 quad_perm:[2,3,0,1] row_mask:0xf bank_mask:0xf
    s_nop 1
    v_add_f32_dpp v132, v132, v132 row_half_mirror row_mask:0xf bank_mask:0xf
    s_nop 1
    v_add_f32_dpp v132, v132, v132 row_mirror row_mask:0xf bank_mask:0xf
    v_mov_b32 v134, v132
    s_nop 1
    v_permlane16_swap_b32 v132, v134
    v_add_f32 v132, v132, v134
    v_mov_b32 v134, v132
    s_nop 1
    v_permlane32_swap_b32 v132, v134
    v_add_f32 v132, v132, v134
    v_mul_f32 v132, 0x3b000000, v132
    v_cvt_pk_bf16_f32 v133, v132, v132
    v_sub_f32 v124, v116, v132
    v_sub_f32 v125, v117, v132
    v_sub_f32 v126, v118, v132
    v_sub_f32 v127, v119, v132
    v_sub_f32 v128, v120, v132
    v_sub_f32 v129, v121, v132
    v_sub_f32 v130, v122, v132
    v_sub_f32 v131, v123, v132
    v_lshlrev_b32 v133, 16, v133
    v_mul_f32 v132, v124, v124
    v_mul_f32 v124, v125, v125
    v_fmac_f32 v124, v126, v126
    v_fmac_f32 v132, v127, v127
    v_fmac_f32 v124, v128, v128
    v_fmac_f32 v132, v129, v129
    v_fmac_f32 v124, v130, v130
    v_fmac_f32 v132, v131, v131
    v_add_f32 v132, v132, v124
    v_sub_f32 v116, v116, v133
    v_sub_f32 v117, v117, v133
    v_sub_f32 v118, v118, v133
    v_sub_f32 v119, v119, v133
    v_sub_f32 v120, v120, v133
    v_sub_f32 v121, v121, v133
    v_sub_f32 v122, v122, v133
    v_sub_f32 v123, v123, v133
    v_add_f32_dpp v132, v132, v132 quad_perm:[1,0,3,2] row_mask:0xf bank_mask:0xf
    s_nop 1
    v_add_f32_dpp v132, v132, v132 quad_perm:[2,3,0,1] row_mask:0xf bank_mask:0xf
    s_nop 1
    v_add_f32_dpp v132, v132, v132 row_half_mirror row_mask:0xf bank_mask:0xf
    s_nop 1
    v_add_f32_dpp v132, v132, v132 row_mirror row_mask:0xf bank_mask:0xf
    v_mov_b32 v134, v132
    s_nop 1
    v_permlane16_swap_b32 v132, v134
    v_add_f32 v132, v132, v134
    v_mov_b32 v134, v132
    s_nop 1
    v_permlane32_swap_b32 v132, v134
    v_add_f32 v132, v132, v134
    v_cvt_pk_bf16_f32 v112, v116, v117
    v_cvt_pk_bf16_f32 v113, v118, v119
    v_cvt_pk_bf16_f32 v114, v120, v121
    v_cvt_pk_bf16_f32 v115, v122, v123
    v_mul_f32 v132, 0x3b000000, v132
    v_cvt_pk_bf16_f32 v132, v132, v132
    v_lshlrev_b32 v132, 16, v132
    v_add_f32 v132, 0x3727c5ac, v132
    v_cvt_pk_bf16_f32 v132, v132, v132
    v_lshlrev_b32 v132, 16, v132
    v_sqrt_f32 v132, v132
    s_nop 0
    v_cvt_pk_bf16_f32 v132, v132, v132
    v_lshlrev_b32 v132, 16, v132
    v_rcp_f32 v132, v132
    v_lshlrev_b32 v116, 16, v112
    v_and_b32 v117, s90, v112
    v_lshlrev_b32 v118, 16, v113
    v_and_b32 v119, s90, v113
    v_lshlrev_b32 v120, 16, v114
    v_and_b32 v121, s90, v114
    v_lshlrev_b32 v122, 16, v115
    v_and_b32 v123, s90, v115
    v_mul_f32 v116, v132, v116
    v_mul_f32 v117, v132, v117
    v_mul_f32 v118, v132, v118
    v_mul_f32 v119, v132, v119
    v_mul_f32 v120, v132, v120
    v_mul_f32 v121, v132, v121
    v_mul_f32 v122, v132, v122
    v_mul_f32 v123, v132, v123
    v_cvt_pk_bf16_f32 v112, v116, v117
    v_cvt_pk_bf16_f32 v113, v118, v119
    v_cvt_pk_bf16_f32 v114, v120, v121
    v_cvt_pk_bf16_f32 v115, v122, v123
    ds_bpermute_b32 v116, v11, v112
    ds_bpermute_b32 v117, v11, v113
    ds_bpermute_b32 v118, v11, v114
    ds_bpermute_b32 v119, v11, v115
    v_and_b32 v8, 2, v0
    v_cmp_eq_u32 vcc, 0, v8
    v_and_b32 v8, 4, v0
    v_cmp_eq_u32 s[12:13], 0, v8
    v_and_b32 v8, 1, v0
    v_lshlrev_b32 v8, 4, v8
    s_waitcnt lgkmcnt(0)
    v_cndmask_b32 v116, v117, v116, vcc
    v_cndmask_b32 v118, v119, v118, vcc
    v_cndmask_b32 v24, v118, v116, s[12:13]
    v_lshrrev_b32 v24, v8, v24
    s_waitcnt vmcnt(0) lgkmcnt(0)
    v_lshlrev_b32 v24, 16, v24
    v_lshlrev_b32 v64, 16, v32
    v_and_b32 v65, s90, v32
    v_lshlrev_b32 v66, 16, v33
    v_and_b32 v67, s90, v33
    v_lshlrev_b32 v68, 16, v34
    v_and_b32 v69, s90, v34
    v_lshlrev_b32 v70, 16, v35
    v_and_b32 v71, s90, v35
    v_lshlrev_b32 v72, 16, v36
    v_and_b32 v73, s90, v36
    v_lshlrev_b32 v74, 16, v37
    v_and_b32 v75, s90, v37
    v_lshlrev_b32 v76, 16, v38
    v_and_b32 v77, s90, v38
    v_lshlrev_b32 v78, 16, v40
    v_and_b32 v79, s90, v40
    v_lshlrev_b32 v80, 16, v41
    v_and_b32 v81, s90, v41
    v_lshlrev_b32 v82, 16, v42
    v_and_b32 v83, s90, v42
    v_lshlrev_b32 v84, 16, v43
    v_and_b32 v85, s90, v43
    v_lshlrev_b32 v86, 16, v44
    v_and_b32 v87, s90, v44
    v_lshlrev_b32 v88, 16, v45
    v_and_b32 v89, s90, v45
    v_lshlrev_b32 v90, 16, v46
    v_and_b32 v91, s90, v46
    v_lshlrev_b32 v92, 16, v48
    v_and_b32 v93, s90, v48
    v_lshlrev_b32 v94, 16, v49
    v_and_b32 v95, s90, v49
    v_lshlrev_b32 v96, 16, v50
    v_and_b32 v97, s90, v50
    v_lshlrev_b32 v98, 16, v51
    v_and_b32 v99, s90, v51
    v_lshlrev_b32 v100, 16, v52
    v_and_b32 v101, s90, v52
    v_lshlrev_b32 v102, 16, v53
    v_and_b32 v103, s90, v53
    v_lshlrev_b32 v104, 16, v54
    v_and_b32 v105, s90, v54
    v_mov_b32 v25, s93
    s_lshl_b32 s6, s15, 6
    s_add_u32 s6, s6, 161152
    v_mov_b32 v27, s6
    s_mov_b32 s7, 0
    s_nop 3
L_mlp_loop:
    v_readlane_b32 s14, v24, s7
    s_nop 1
    v_fma_f32 v112, s14, v64, v78
    v_fma_f32 v113, s14, v65, v79
    v_fma_f32 v114, s14, v66, v80
    v_fma_f32 v115, s14, v67, v81
    v_fma_f32 v116, s14, v68, v82
    v_fma_f32 v117, s14, v69, v83
    v_fma_f32 v118, s14, v70, v84
    v_fma_f32 v119, s14, v71, v85
    v_fma_f32 v120, s14, v72, v86
    v_fma_f32 v121, s14, v73, v87
    v_fma_f32 v122, s14, v74, v88
    v_fma_f32 v123, s14, v75, v89
    v_fma_f32 v124, s14, v76, v90
    v_fma_f32 v125, s14, v77, v91
    v_mul_f32 v128, v112, v112
    v_mul_f32 v129, v113, v113
    v_mul_f32 v130, v114, v114
    v_mul_f32 v131, v115, v115
    v_mul_f32 v132, v116, v116
    v_mul_f32 v133, v117, v117
    v_mul_f32 v134, v118, v118
    v_mul_f32 v135, v119, v119
    v_mul_f32 v136, v120, v120
    v_mul_f32 v137, v121, v121
    v_mul_f32 v138, v122, v122
    v_mul_f32 v139, v123, v123
    v_mul_f32 v140, v124, v124
    v_mul_f32 v141, v125, v125
    v_fma_f32 v128, v128, s94, v25
    v_fma_f32 v129, v129, s94, v25
    v_fma_f32 v130, v130, s94, v25
    v_fma_f32 v131, v131, s94, v25
    v_fma_f32 v132, v132, s94, v25
    v_fma_f32 v133, v133, s94, v25
    v_fma_f32 v134, v134, s94, v25
    v_fma_f32 v135, v135, s94, v25
    v_fma_f32 v136, v136, s94, v25
    v_fma_f32 v137, v137, s94, v25
    v_fma_f32 v138, v138, s94, v25
    v_fma_f32 v139, v139, s94, v25
    v_fma_f32 v140, v140, s94, v25
    v_fma_f32 v141, v141, s94, v25
    v_mul_f32 v128, v128, v112
    v_mul_f32 v129, v129, v113
    v_mul_f32 v130, v130, v114
    v_mul_f32 v131, v131, v115
    v_mul_f32 v132, v132, v116
    v_mul_f32 v133, v133, v117
    v_mul_f32 v134, v134, v118
    v_mul_f32 v135, v135, v119
    v_mul_f32 v136, v136, v120
    v_mul_f32 v137, v137, v121
    v_mul_f32 v138, v138, v122
    v_mul_f32 v139, v139, v123
    v_mul_f32 v140, v140, v124
    v_mul_f32 v141, v141, v125
    v_exp_f32 v128, v128
    v_mul_f32 v112, v112, v92
    v_exp_f32 v129, v129
    v_mul_f32 v113, v113, v93
    v_exp_f32 v130, v130
    v_mul_f32 v114, v114, v94
    v_exp_f32 v131, v131
    v_mul_f32 v115, v115, v95
    v_exp_f32 v132, v132
    v_mul_f32 v116, v116, v96
    v_exp_f32 v133, v133
    v_mul_f32 v117, v117, v97
    v_exp_f32 v134, v134
    v_mul_f32 v118, v118, v98
    v_exp_f32 v135, v135
    v_mul_f32 v119, v119, v99
    v_exp_f32 v136, v136
    v_mul_f32 v120, v120, v100
    v_exp_f32 v137, v137
    v_mul_f32 v121, v121, v101
    v_exp_f32 v138, v138
    v_mul_f32 v122, v122, v102
    v_exp_f32 v139, v139
    v_mul_f32 v123, v123, v103
    v_exp_f32 v140, v140
    v_mul_f32 v124, v124, v104
    v_exp_f32 v141, v141
    v_mul_f32 v125, v125, v105
    v_add_f32 v128, 1.0, v128
    v_add_f32 v129, 1.0, v129
    v_add_f32 v130, 1.0, v130
    v_add_f32 v131, 1.0, v131
    v_add_f32 v132, 1.0, v132
    v_add_f32 v133, 1.0, v133
    v_add_f32 v134, 1.0, v134
    v_add_f32 v135, 1.0, v135
    v_add_f32 v136, 1.0, v136
    v_add_f32 v137, 1.0, v137
    v_add_f32 v138, 1.0, v138
    v_add_f32 v139, 1.0, v139
    v_add_f32 v140, 1.0, v140
    v_add_f32 v141, 1.0, v141
    v_rcp_f32 v128, v128
    v_rcp_f32 v129, v129
    v_rcp_f32 v130, v130
    v_rcp_f32 v131, v131
    v_rcp_f32 v132, v132
    v_rcp_f32 v133, v133
    v_rcp_f32 v134, v134
    v_rcp_f32 v135, v135
    v_rcp_f32 v136, v136
    v_rcp_f32 v137, v137
    v_rcp_f32 v138, v138
    v_rcp_f32 v139, v139
    v_rcp_f32 v140, v140
    v_rcp_f32 v141, v141
    v_mul_f32 v26, v112, v128
    v_mul_f32 v112, v113, v129
    v_fmac_f32 v112, v114, v130
    v_fmac_f32 v26, v115, v131
    v_fmac_f32 v112, v116, v132
    v_fmac_f32 v26, v117, v133
    v_fmac_f32 v112, v118, v134
    v_fmac_f32 v26, v119, v135
    v_fmac_f32 v112, v120, v136
    v_fmac_f32 v26, v121, v137
    v_fmac_f32 v112, v122, v138
    v_fmac_f32 v26, v123, v139
    v_fmac_f32 v112, v124, v140
    v_fmac_f32 v26, v125, v141
    v_add_f32 v26, v26, v112
    s_nop 1
    v_add_f32_dpp v26, v26, v26 quad_perm:[1,0,3,2] row_mask:0xf bank_mask:0xf
    s_nop 1
    v_add_f32_dpp v26, v26, v26 quad_perm:[2,3,0,1] row_mask:0xf bank_mask:0xf
    s_nop 1
    v_add_f32_dpp v26, v26, v26 row_half_mirror row_mask:0xf bank_mask:0xf
    s_nop 1
    v_add_f32_dpp v26, v26, v26 row_mirror row_mask:0xf bank_mask:0xf
    s_nop 1
    v_add_f32_dpp v26, v26, v26 row_bcast:15 row_mask:0xa bank_mask:0xf
    s_nop 1
    v_add_f32_dpp v26, v26, v26 row_bcast:31 row_mask:0xc bank_mask:0xf
    s_mov_b32 exec_lo, 0
    s_mov_b32 exec_hi, 0x80000000
    ds_write_b32 v27, v26
    v_add_u32 v27, 4, v27
    s_mov_b64 exec, -1
    s_add_u32 s7, s7, 1
    s_cmp_lt_u32 s7, 16
    s_cbranch_scc1 L_mlp_loop
    s_mov_b32 s14, 3
    s_waitcnt lgkmcnt(0)
    s_mov_b64 exec, 1
    ds_add_u32 v6, v7 offset:29900
    s_mov_b64 exec, -1
    s_cmp_eq_u32 s3, 7
    s_cbranch_scc1 L_final
    v_mov_b32 v28, 0
    s_and_b32 s47, s4, 0xffff0000
    s_and_b32 s78, s2, 0x78
    s_and_b32 s79, s2, 7
    s_lshr_b32 s88, s2, 7
    s_lshl1_add_u32 s79, s79, s88
    s_lshl_b32 s79, s79, 6
    s_add_u32 s79, s79, 0x10000
    s_mov_b32 s48, 0
    s_mov_b32 s55, 1
    s_mov_b32 s81, 0
    s_mov_b32 s50, 0
    s_not_b32 s88, s47
    v_mov_b32 v113, s88
    v_mov_b32 v122, s88
    v_lshlrev_b32 v124, 2, v0
    v_lshlrev_b32 v125, 6, v0
    ds_read_b32 v119, v6 offset:29832
    s_waitcnt lgkmcnt(0)
    v_readfirstlane_b32 s53, v119
    s_nop 0
    s_cmp_eq_u32 s53, 0
    s_cselect_b32 s50, 0, 3
    s_mov_b32 s45, 0
    s_mov_b32 s49, 62
    v_add_u32 v112, 29824, v6
L_fast:
    ds_read_b32 v119, v6 offset:29828
    ds_read_b32 v120, v112
    s_memrealtime s[92:93]
    s_waitcnt lgkmcnt(0)
    v_readfirstlane_b32 s95, v120
    v_readfirstlane_b32 s94, v119
    s_mul_i32 s93, s92, 38
    s_cmp_ge_u32 s95, s49
    s_cbranch_scc1 L_balend
    s_lshl_b32 s94, s94, 7
    s_sub_u32 s94, s94, s93
    s_cmp_eq_u32 s53, 0
    s_cbranch_scc1 L_balskip
    s_add_u32 s88, s53, s93
    s_cmp_ge_i32 s88, 64640
    s_cselect_b32 s88, 64, 0
    v_mov_b32 v121, s88
    v_mov_b32 v120, s53
    s_sub_i32 s95, s53, s94
    s_add_u32 s48, s48, 3
    s_and_b32 s88, s48, 7
    s_mul_i32 s88, s88, 128
    s_add_i32 s88, s88, 5184
    s_add_i32 s95, s95, s88
    s_ashr_i32 s95, s95, 8
    s_and_b32 s95, s95, -4
    s_add_i32 s88, s95, 0
    s_max_i32 s88, s88, 16
    s_min_i32 s88, s88, 40
    s_max_i32 s95, s95, 12
    s_min_i32 s95, s95, 32
    v_mov_b32 v116, s95
    v_mov_b32 v117, s88
    s_mov_b64 exec, 1
    ds_write_b64 v6, v[116:117] offset:29856
    ds_write_b64 v6, v[120:121] offset:29832
    s_mov_b64 exec, -1
L_balskip:
    s_sub_u32 s55, s55, 1
    s_cmp_eq_u32 s55, 0
    s_cbranch_scc1 L_look
    s_sleep 3
    s_branch L_fast
L_look:
    s_bfe_u32 s93, s94, 0x100004
    s_mov_b64 exec, 0xffff
    s_cmp_lg_u32 s50, 1
    s_cbranch_scc1 L_nonew
    s_mov_b32 s95, 0x10000
    s_cmp_eq_u32 s78, 0
    s_waitcnt vmcnt(2)
    s_cbranch_scc1 L_look2
    s_waitcnt vmcnt(0)
L_look2:
    v_xor_b32 v116, s47, v122
    v_cmp_gt_u32 vcc, s95, v116
    s_nop 1
    v_cndmask_b32 v113, v113, v122, vcc
    v_xor_b32 v116, s47, v113
    v_cmp_gt_u32 vcc, s95, v116
    v_subrev_u32 v116, s93, v116
    v_bfe_i32 v116, v116, 0, 16
    v_cndmask_b32 v116, 0, v116, vcc
    s_nop 1
    v_add_u32_dpp v116, v116, v116 quad_perm:[1,0,3,2] row_mask:0xf bank_mask:0xf
    s_nop 1
    v_add_u32_dpp v116, v116, v116 quad_perm:[2,3,0,1] row_mask:0xf bank_mask:0xf
    s_nop 1
    v_add_u32_dpp v116, v116, v116 row_half_mirror row_mask:0xf bank_mask:0xf
    s_nop 1
    v_add_u32_dpp v116, v116, v116 row_mirror row_mask:0xf bank_mask:0xf
    s_bcnt1_i32_b32 s76, vcc_lo
    v_readfirstlane_b32 s72, v116
    s_nop 0
    s_add_u32 s72, s72, s94
    s_or_b32 s72, s72, 1
    s_cmp_ge_u32 s76, 13
    s_cselect_b32 s53, s72, s53
    s_cselect_b32 s50, 5, 1
L_nonew:
    s_sub_u32 s50, s50, 1
    s_cmp_gt_i32 s50, 1
    s_cbranch_scc1 L_noload
    s_mov_b32 s50, 1
    s_sub_u32 s89, s92, 124
    s_bfe_u32 s89, s89, 0x50006
    s_lshl_b32 s89, s89, 10
    s_add_u32 s89, s89, 0x10000
    buffer_load_dword v122, v125, s[84:87], s89 offen
L_noload:
    s_cmp_lg_u32 s78, 0
    s_cbranch_scc1 L_nolead
    s_or_b32 s88, s93, s47
    v_mov_b32 v114, s88
    s_bfe_u32 s88, s92, 0x50006
    s_lshl_b32 s88, s88, 10
    s_add_u32 s88, s88, s79
    buffer_store_dword v114, v124, s[84:87], s88 offen sc1
    s_add_u32 s88, s92, 64
    s_bfe_u32 s88, s88, 0x50006
    s_lshl_b32 s88, s88, 10
    s_add_u32 s88, s88, s79
    buffer_store_dword v114, v124, s[84:87], s88 offen sc1
L_nolead:
    s_mov_b64 exec, -1
    s_mov_b32 s55, 4
    s_add_u32 s81, s81, 1
    s_cmp_eq_u32 s45, 2
    s_cbranch_scc1 L_ret2
    s_cmp_lt_u32 s81, 131072
    s_cbranch_scc1 L_fast
L_balend:
    s_mov_b64 exec, -1
    s_cmp_eq_u32 s45, 1
    s_cbranch_scc1 L_ret1
    s_waitcnt vmcnt(0)
    s_cmp_eq_u32 s3, 5
    s_cbranch_scc1 L_bal_back5
    s_branch L_gather56
L_final:
    v_and_b32 v9, 7, v0
    v_lshrrev_b32 v10, 5, v0
    v_lshl_add_u32 v9, v9, 1, v10
    v_lshlrev_b32 v10, 1, v9
    s_lshl_b32 s12, s9, 5
    buffer_load_ushort v11, v10, s[52:55], s12 offen
    v_lshl_add_u32 v9, v9, 2, v6
    v_lshrrev_b32 v12, 3, v0
    v_lshlrev_b32 v12, 10, v12
    v_and_b32 v13, 7, v0
    v_lshl_add_u32 v12, v13, 4, v12
    s_lshr_b32 s6, s9, 3
    s_lshl_b32 s6, s6, 17
    s_and_b32 s7, s9, 7
    s_lshl_b32 s7, s7, 7
    s_add_u32 s6, s6, s7
    s_mov_b32 s10, 0
L_lagain_93:
    ds_read_b32 v16, v6 offset:29900
    s_waitcnt lgkmcnt(0)
    v_readfirstlane_b32 s11, v16
    s_nop 0
    s_cmp_ge_u32 s11, 2
    s_cbranch_scc1 L_lok_92
    s_sleep 1
    s_add_u32 s10, s10, 1
    s_cmp_lt_u32 s10, 4194304
    s_cbranch_scc1 L_lagain_93
L_lok_92:
    ds_read_b32 v40, v9 offset:30080
    ds_read_b32 v41, v9 offset:30144
    s_waitcnt lgkmcnt(0)
    v_add_f32 v40, v40, v41
    v_cvt_pk_bf16_f32 v40, v40, v40
    v_lshlrev_b32 v40, 16, v40
    s_lshl_b32 s95, s95, 16
    v_add_f32 v40, s95, v40
    v_cvt_pk_bf16_f32 v40, v40, v40
    v_lshlrev_b32 v40, 16, v40
    v_mul_f32 v41, s92, v40
    v_exp_f32 v41, -v41
    s_nop 0
    v_add_f32 v41, 1.0, v41
    v_rcp_f32 v41, v41
    s_nop 0
    v_mul_f32 v40, v40, v41
    v_cvt_pk_bf16_f32 v40, v40, v40
    v_lshlrev_b32 v40, 16, v40
    s_mov_b32 s10, 0
L_lagain_95:
    ds_read_b32 v16, v6 offset:29884
    s_waitcnt lgkmcnt(0)
    v_readfirstlane_b32 s11, v16
    s_nop 0
    s_cmp_ge_u32 s11, 4
    s_cbranch_scc1 L_lok_94
    s_sleep 8
    s_add_u32 s10, s10, 1
    s_cmp_lt_u32 s10, 4194304
    s_cbranch_scc1 L_lagain_95
L_lok_94:
    s_mov_b32 s10, 0
L_wo_wait:
    ds_read_b128 v[44:47], v6 offset:29824
    s_waitcnt lgkmcnt(0)
    v_max_u32 v44, v44, v47
    s_nop 0
    v_readfirstlane_b32 s11, v44
    s_nop 0
    s_cmp_ge_u32 s11, 62
    s_cbranch_scc1 L_wo_go
    s_sleep 2
    s_add_u32 s10, s10, 1
    s_cmp_lt_u32 s10, 4194304
    s_cbranch_scc1 L_wo_wait
L_wo_go:
    buffer_load_ushort v60, v10, s[76:79], s12 offen
    s_mov_b32 m0, 131072
    s_nop 0
    buffer_load_dwordx4 v12, s[60:63], s6 offen nt lds
    s_add_u32 s6, s6, 0x2000
    s_mov_b32 m0, 132096
    s_nop 0
    buffer_load_dwordx4 v12, s[60:63], s6 offen nt lds
    s_add_u32 s6, s6, 0x2000
    s_mov_b32 m0, 133120
    s_nop 0
    buffer_load_dwordx4 v12, s[60:63], s6 offen nt lds
    s_add_u32 s6, s6, 0x2000
    s_mov_b32 m0, 134144
    s_nop 0
    buffer_load_dwordx4 v12, s[60:63], s6 offen nt lds
    s_add_u32 s6, s6, 0x2000
    s_mov_b32 m0, 135168
    s_nop 0
    buffer_load_dwordx4 v12, s[60:63], s6 offen nt lds
    s_add_u32 s6, s6, 0x2000
    s_mov_b32 m0, 136192
    s_nop 0
    buffer_load_dwordx4 v12, s[60:63], s6 offen nt lds
    s_add_u32 s6, s6, 0x2000
    s_mov_b32 m0, 137216
    s_nop 0
    buffer_load_dwordx4 v12, s[60:63], s6 offen nt lds
    s_add_u32 s6, s6, 0x2000
    s_mov_b32 m0, 138240
    s_nop 0
    buffer_load_dwordx4 v12, s[60:63], s6 offen nt lds
    s_add_u32 s6, s6, 0x2000
    s_mov_b32 m0, 139264
    s_nop 0
    buffer_load_dwordx4 v12, s[60:63], s6 offen nt lds
    s_add_u32 s6, s6, 0x2000
    s_mov_b32 m0, 140288
    s_nop 0
    buffer_load_dwordx4 v12, s[60:63], s6 offen nt lds
    s_add_u32 s6, s6, 0x2000
    s_mov_b32 m0, 141312
    s_nop 0
    buffer_load_dwordx4 v12, s[60:63], s6 offen nt lds
    s_add_u32 s6, s6, 0x2000
    s_mov_b32 m0, 142336
    s_nop 0
    buffer_load_dwordx4 v12, s[60:63], s6 offen nt lds
    s_add_u32 s6, s6, 0x2000
    s_mov_b32 m0, 143360
    s_nop 0
    buffer_load_dwordx4 v12, s[60:63], s6 offen nt lds
    s_add_u32 s6, s6, 0x2000
    s_mov_b32 m0, 144384
    s_nop 0
    buffer_load_dwordx4 v12, s[60:63], s6 offen nt lds
    s_add_u32 s6, s6, 0x2000
    s_mov_b32 m0, 145408
    s_nop 0
    buffer_load_dwordx4 v12, s[60:63], s6 offen nt lds
    s_add_u32 s6, s6, 0x2000
    s_mov_b32 m0, 146432
    s_nop 0
    buffer_load_dwordx4 v12, s[60:63], s6 offen nt lds
    s_lshl_b32 s7, s9, 11
    s_add_u32 s7, s7, 0x100000
    v_lshlrev_b32 v29, 3, v0
    v_mov_b32 v30, s4
    v_mov_b32 v31, s5
    v_lshlrev_b32 v28, 4, v4
    v_lshrrev_b64 v[42:43], v28, v[30:31]
    v_and_b32 v28, 0xffff, v42
    s_mov_b32 s13, 0x0c0c0400
    s_cmp_eq_u32 s9, 0
    s_cselect_b32 s96, 1, 0
    s_mov_b32 s97, 0
    s_waitcnt vmcnt(0)
    v_lshlrev_b32 v11, 16, v11
    s_mov_b64 exec, 1
    ds_write_b32 v6, v7 offset:29892
    s_mov_b64 exec, -1
    s_barrier
L_fin:
    s_sleep 12
    v_mov_b32 v48, 0
    v_mov_b32 v49, 0
    buffer_atomic_or_x2 v[48:49], v29, s[84:87], s7 offen offset:0 sc0
    v_mov_b32 v50, 0
    v_mov_b32 v51, 0
    buffer_atomic_or_x2 v[50:51], v29, s[84:87], s7 offen offset:512 sc0
    v_mov_b32 v52, 0
    v_mov_b32 v53, 0
    buffer_atomic_or_x2 v[52:53], v29, s[84:87], s7 offen offset:1024 sc0
    v_mov_b32 v54, 0
    v_mov_b32 v55, 0
    buffer_atomic_or_x2 v[54:55], v29, s[84:87], s7 offen offset:1536 sc0
    s_mov_b64 s[52:53], -1
    s_mov_b64 s[54:55], -1
    s_mov_b64 s[56:57], -1
    s_mov_b64 s[58:59], -1
    s_mov_b32 s10, 0
    s_sleep 9
    v_mov_b32 v56, 0
    v_mov_b32 v57, 0
    buffer_atomic_or_x2 v[56:57], v29, s[84:87], s7 offen offset:0 sc0
    v_mov_b32 v58, 0
    v_mov_b32 v59, 0
    buffer_atomic_or_x2 v[58:59], v29, s[84:87], s7 offen offset:512 sc0
    v_mov_b32 v60, 0
    v_mov_b32 v61, 0
    buffer_atomic_or_x2 v[60:61], v29, s[84:87], s7 offen offset:1024 sc0
    v_mov_b32 v62, 0
    v_mov_b32 v63, 0
    buffer_atomic_or_x2 v[62:63], v29, s[84:87], s7 offen offset:1536 sc0
L_fin_again:
    s_waitcnt vmcnt(4)
    v_perm_b32 v44, v49, v48, s13
    v_perm_b32 v45, v51, v50, s13
    v_perm_b32 v46, v53, v52, s13
    v_perm_b32 v47, v55, v54, s13
    v_cmp_ne_u32 s[64:65], v28, v44
    v_cmp_ne_u32 s[66:67], v28, v45
    v_cmp_ne_u32 s[68:69], v28, v46
    v_cmp_ne_u32 s[70:71], v28, v47
    s_and_b64 s[64:65], s[64:65], s[52:53]
    s_and_b64 s[66:67], s[66:67], s[54:55]
    s_and_b64 s[68:69], s[68:69], s[56:57]
    s_and_b64 s[70:71], s[70:71], s[58:59]
    s_or_b64 s[92:93], s[64:65], s[66:67]
    s_or_b64 s[94:95], s[68:69], s[70:71]
    s_or_b64 s[92:93], s[92:93], s[94:95]
    s_cbranch_scc0 L_fin_ok0
    v_xor_b32 v44, v28, v44
    v_xor_b32 v45, v28, v45
    v_xor_b32 v46, v28, v46
    v_xor_b32 v47, v28, v47
    v_or_b32_dpp v44, v44, v44 quad_perm:[1,0,3,2] row_mask:0xf bank_mask:0xf
    v_or_b32_dpp v45, v45, v45 quad_perm:[1,0,3,2] row_mask:0xf bank_mask:0xf
    v_or_b32_dpp v46, v46, v46 quad_perm:[1,0,3,2] row_mask:0xf bank_mask:0xf
    v_or_b32_dpp v47, v47, v47 quad_perm:[1,0,3,2] row_mask:0xf bank_mask:0xf
    v_or_b32_dpp v44, v44, v44 quad_perm:[2,3,0,1] row_mask:0xf bank_mask:0xf
    v_or_b32_dpp v45, v45, v45 quad_perm:[2,3,0,1] row_mask:0xf bank_mask:0xf
    v_or_b32_dpp v46, v46, v46 quad_perm:[2,3,0,1] row_mask:0xf bank_mask:0xf
    v_or_b32_dpp v47, v47, v47 quad_perm:[2,3,0,1] row_mask:0xf bank_mask:0xf
    v_or_b32_dpp v44, v44, v44 row_half_mirror row_mask:0xf bank_mask:0xf
    v_or_b32_dpp v45, v45, v45 row_half_mirror row_mask:0xf bank_mask:0xf
    v_or_b32_dpp v46, v46, v46 row_half_mirror row_mask:0xf bank_mask:0xf
    v_or_b32_dpp v47, v47, v47 row_half_mirror row_mask:0xf bank_mask:0xf
    v_cmp_eq_u32 s[64:65], 0, v44
    v_cmp_eq_u32 s[66:67], 0, v45
    v_cmp_eq_u32 s[68:69], 0, v46
    v_cmp_eq_u32 s[70:71], 0, v47
    s_and_b64 exec, s[64:65], s[52:53]
    v_mov_b32 v32, v48
    v_mov_b32 v33, v49
    s_and_b64 exec, s[66:67], s[54:55]
    v_mov_b32 v34, v50
    v_mov_b32 v35, v51
    s_and_b64 exec, s[68:69], s[56:57]
    v_mov_b32 v36, v52
    v_mov_b32 v37, v53
    s_and_b64 exec, s[70:71], s[58:59]
    v_mov_b32 v38, v54
    v_mov_b32 v39, v55
    s_andn2_b64 s[52:53], s[52:53], s[64:65]
    s_mov_b64 exec, s[52:53]
    v_mov_b32 v48, 0
    v_mov_b32 v49, 0
    buffer_atomic_or_x2 v[48:49], v29, s[84:87], s7 offen offset:0 sc0
    s_andn2_b64 s[54:55], s[54:55], s[66:67]
    s_mov_b64 exec, s[54:55]
    v_mov_b32 v50, 0
    v_mov_b32 v51, 0
    buffer_atomic_or_x2 v[50:51], v29, s[84:87], s7 offen offset:512 sc0
    s_andn2_b64 s[56:57], s[56:57], s[68:69]
    s_mov_b64 exec, s[56:57]
    v_mov_b32 v52, 0
    v_mov_b32 v53, 0
    buffer_atomic_or_x2 v[52:53], v29, s[84:87], s7 offen offset:1024 sc0
    s_andn2_b64 s[58:59], s[58:59], s[70:71]
    s_mov_b64 exec, s[58:59]
    v_mov_b32 v54, 0
    v_mov_b32 v55, 0
    buffer_atomic_or_x2 v[54:55], v29, s[84:87], s7 offen offset:1536 sc0
    s_mov_b64 exec, -1
    s_waitcnt vmcnt(4)
    v_perm_b32 v44, v57, v56, s13
    v_perm_b32 v45, v59, v58, s13
    v_perm_b32 v46, v61, v60, s13
    v_perm_b32 v47, v63, v62, s13
    v_cmp_ne_u32 s[64:65], v28, v44
    v_cmp_ne_u32 s[66:67], v28, v45
    v_cmp_ne_u32 s[68:69], v28, v46
    v_cmp_ne_u32 s[70:71], v28, v47
    s_and_b64 s[64:65], s[64:65], s[52:53]
    s_and_b64 s[66:67], s[66:67], s[54:55]
    s_and_b64 s[68:69], s[68:69], s[56:57]
    s_and_b64 s[70:71], s[70:71], s[58:59]
    s_or_b64 s[92:93], s[64:65], s[66:67]
    s_or_b64 s[94:95], s[68:69], s[70:71]
    s_or_b64 s[92:93], s[92:93], s[94:95]
    s_cbranch_scc0 L_fin_ok1
    v_xor_b32 v44, v28, v44
    v_xor_b32 v45, v28, v45
    v_xor_b32 v46, v28, v46
    v_xor_b32 v47, v28, v47
    v_or_b32_dpp v44, v44, v44 quad_perm:[1,0,3,2] row_mask:0xf bank_mask:0xf
    v_or_b32_dpp v45, v45, v45 quad_perm:[1,0,3,2] row_mask:0xf bank_mask:0xf
    v_or_b32_dpp v46, v46, v46 quad_perm:[1,0,3,2] row_mask:0xf bank_mask:0xf
    v_or_b32_dpp v47, v47, v47 quad_perm:[1,0,3,2] row_mask:0xf bank_mask:0xf
    v_or_b32_dpp v44, v44, v44 quad_perm:[2,3,0,1] row_mask:0xf bank_mask:0xf
    v_or_b32_dpp v45, v45, v45 quad_perm:[2,3,0,1] row_mask:0xf bank_mask:0xf
    v_or_b32_dpp v46, v46, v46 quad_perm:[2,3,0,1] row_mask:0xf bank_mask:0xf
    v_or_b32_dpp v47, v47, v47 quad_perm:[2,3,0,1] row_mask:0xf bank_mask:0xf
    v_or_b32_dpp v44, v44, v44 row_half_mirror row_mask:0xf bank_mask:0xf
    v_or_b32_dpp v45, v45, v45 row_half_mirror row_mask:0xf bank_mask:0xf
    v_or_b32_dpp v46, v46, v46 row_half_mirror row_mask:0xf bank_mask:0xf
    v_or_b32_dpp v47, v47, v47 row_half_mirror row_mask:0xf bank_mask:0xf
    v_cmp_eq_u32 s[64:65], 0, v44
    v_cmp_eq_u32 s[66:67], 0, v45
    v_cmp_eq_u32 s[68:69], 0, v46
    v_cmp_eq_u32 s[70:71], 0, v47
    s_and_b64 exec, s[64:65], s[52:53]
    v_mov_b32 v32, v56
    v_mov_b32 v33, v57
    s_and_b64 exec, s[66:67], s[54:55]
    v_mov_b32 v34, v58
    v_mov_b32 v35, v59
    s_and_b64 exec, s[68:69], s[56:57]
    v_mov_b32 v36, v60
    v_mov_b32 v37, v61
    s_and_b64 exec, s[70:71], s[58:59]
    v_mov_b32 v38, v62
    v_mov_b32 v39, v63
    s_andn2_b64 s[52:53], s[52:53], s[64:65]
    s_mov_b64 exec, s[52:53]
    v_mov_b32 v56, 0
    v_mov_b32 v57, 0
    buffer_atomic_or_x2 v[56:57], v29, s[84:87], s7 offen offset:0 sc0
    s_andn2_b64 s[54:55], s[54:55], s[66:67]
    s_mov_b64 exec, s[54:55]
    v_mov_b32 v58, 0
    v_mov_b32 v59, 0
    buffer_atomic_or_x2 v[58:59], v29, s[84:87], s7 offen offset:512 sc0
    s_andn2_b64 s[56:57], s[56:57], s[68:69]
    s_mov_b64 exec, s[56:57]
    v_mov_b32 v60, 0
    v_mov_b32 v61, 0
    buffer_atomic_or_x2 v[60:61], v29, s[84:87], s7 offen offset:1024 sc0
    s_andn2_b64 s[58:59], s[58:59], s[70:71]
    s_mov_b64 exec, s[58:59]
    v_mov_b32 v62, 0
    v_mov_b32 v63, 0
    buffer_atomic_or_x2 v[62:63], v29, s[84:87], s7 offen offset:1536 sc0
    s_mov_b64 exec, -1
    s_add_u32 s10, s10, 1
    s_cmp_lt_u32 s10, 131072
    s_cbranch_scc1 L_fin_again
L_fin_ok1:
    v_cndmask_b32 v32, v32, v56, s[52:53]
    v_cndmask_b32 v33, v33, v57, s[52:53]
    v_cndmask_b32 v34, v34, v58, s[54:55]
    v_cndmask_b32 v35, v35, v59, s[54:55]
    v_cndmask_b32 v36, v36, v60, s[56:57]
    v_cndmask_b32 v37, v37, v61, s[56:57]
    v_cndmask_b32 v38, v38, v62, s[58:59]
    v_cndmask_b32 v39, v39, v63, s[58:59]
    s_branch L_fin_ok
L_fin_ok0:
    v_cndmask_b32 v32, v32, v48, s[52:53]
    v_cndmask_b32 v33, v33, v49, s[52:53]
    v_cndmask_b32 v34, v34, v50, s[54:55]
    v_cndmask_b32 v35, v35, v51, s[54:55]
    v_cndmask_b32 v36, v36, v52, s[56:57]
    v_cndmask_b32 v37, v37, v53, s[56:57]
    v_cndmask_b32 v38, v38, v54, s[58:59]
    v_cndmask_b32 v39, v39, v55, s[58:59]
L_fin_ok:
    v_add_f32 v44, v32, v34
    v_add_f32 v45, v33, v35
    v_add_f32 v46, v36, v38
    v_add_f32 v47, v37, v39
    v_add_f32 v44, v44, v46
    v_add_f32 v45, v45, v47
    s_nop 1
    v_permlane32_swap_b32 v44, v45
    v_add_f32 v44, v44, v45
    v_mov_b32 v45, v44
    s_nop 1
    v_permlane16_swap_b32 v44, v45
    v_add_f32 v44, v44, v45
    s_nop 1
    v_add_f32_dpp v44, v44, v44 row_ror:8 row_mask:0xf bank_mask:0xf
    v_cvt_pk_bf16_f32 v44, v44, v44
    v_lshlrev_b32 v44, 16, v44
    v_mul_f32 v44, v44, v40
    v_cvt_pk_bf16_f32 v44, v44, v44
    v_lshlrev_b32 v44, 16, v44
    v_add_f32 v44, v44, v11
    v_cvt_pk_bf16_f32 v44, v44, v44
    s_mov_b32 exec_lo, 0xff
    s_mov_b32 exec_hi, 0xff
    buffer_store_short v44, v10, s[76:79], s12 offen
    s_mov_b64 exec, s[96:97]
    buffer_store_dwordx2 v[30:31], off, s[84:87], 0 offset:0 sc1
L_done:
L_end:
    s_endpgm
L_loader2:
    v_lshlrev_b32 v9, 1, v2
    v_xor_b32 v9, v9, v5
    v_lshl_add_u32 v21, v9, 4, v8
    v_xor_b32 v22, 128, v21
    v_mov_b32 v6, 0x20000
    v_and_b32 v23, 3, v0
    v_lshl_add_u32 v23, v23, 2, v6
    v_and_b32 v27, 1, v0
    v_lshl_add_u32 v26, v27, 2, v6
    v_mul_u32_u24 v27, 3, v27
    v_sub_u32 v27, 3, v27
    s_and_b32 s6, s2, 7
    s_cmp_eq_u32 s6, 3
    s_cselect_b32 s6, 16, 16
    v_cmp_le_u32 vcc, 56, v0
    s_nop 1
    v_cndmask_b32 v28, 0, 1, vcc
    v_cmp_gt_u32 vcc, s6, v0
    s_nop 1
    v_cndmask_b32 v28, v28, 2, vcc
    v_lshl_add_u32 v28, v28, 2, v6
    s_mov_b32 s12, 4
    s_mov_b32 s14, 32
    s_barrier
    ds_read_b32 v24, v23 offset:29840
    ds_read_b32 v25, v28 offset:29856
    s_waitcnt lgkmcnt(0)
L_blk:
    s_waitcnt lgkmcnt(2)
    v_readlane_b32 s8, v24, s12
    v_readlane_b32 s15, v25, s12
    s_cmp_lt_i32 s8, s12
    s_cbranch_scc1 L_full
L_go:
    s_sub_u32 s6, s14, s15
    s_cmp_gt_u32 s15, 28
    v_lshrrev_b32 v8, v27, s6
    s_cbranch_scc1 L_hi_2
    s_cmp_ge_u32 s15, 28
    s_waitcnt vmcnt(28)
    s_cbranch_scc1 L_w_1
    s_cmp_ge_u32 s15, 24
    s_waitcnt vmcnt(24)
    s_cbranch_scc1 L_w_1
    s_cmp_ge_u32 s15, 20
    s_waitcnt vmcnt(20)
    s_cbranch_scc1 L_w_1
    s_cmp_ge_u32 s15, 16
    s_waitcnt vmcnt(16)
    s_cbranch_scc1 L_w_1
    s_waitcnt vmcnt(12)
L_w_1:
    buffer_load_dwordx4 v17, s[44:47], s5 offen offset:0 nt lds
    buffer_load_dwordx4 v18, s[44:47], s5 offen offset:1024 nt lds
    buffer_load_dwordx4 v19, s[44:47], s5 offen offset:2048 nt lds
    buffer_load_dwordx4 v20, s[44:47], s5 offen offset:3072 nt lds
    s_addk_i32 m0, 4096
    ds_read_b32 v24, v23 offset:29840
    ds_read_b32 v25, v28 offset:29856
    s_addk_i32 s5, 16384
    s_and_b32 s5, s5, 0xfffff
    s_addk_i32 s14, 4
    ds_write_b32 v26, v8 offset:29824
    s_sub_u32 s6, s14, s15
    s_cmp_gt_u32 s15, 28
    v_lshrrev_b32 v9, v27, s6
    s_cbranch_scc1 L_hi_4
    s_cmp_ge_u32 s15, 28
    s_waitcnt vmcnt(28)
    s_cbranch_scc1 L_w_3
    s_cmp_ge_u32 s15, 24
    s_waitcnt vmcnt(24)
    s_cbranch_scc1 L_w_3
    s_cmp_ge_u32 s15, 20
    s_waitcnt vmcnt(20)
    s_cbranch_scc1 L_w_3
    s_cmp_ge_u32 s15, 16
    s_waitcnt vmcnt(16)
    s_cbranch_scc1 L_w_3
    s_waitcnt vmcnt(12)
L_w_3:
    buffer_load_dwordx4 v17, s[44:47], s5 offen offset:0 nt lds
    buffer_load_dwordx4 v18, s[44:47], s5 offen offset:1024 nt lds
    buffer_load_dwordx4 v19, s[44:47], s5 offen offset:2048 nt lds
    buffer_load_dwordx4 v20, s[44:47], s5 offen offset:3072 nt lds
    s_addk_i32 m0, 4096
    s_addk_i32 s5, 16384
    s_and_b32 s5, s5, 0xfffff
    s_addk_i32 s14, 4
    ds_write_b32 v26, v9 offset:29824
    s_and_b32 m0, m0, 0x1ffff
    s_add_u32 s12, s12, 1
    s_and_b32 s6, s12, 31
    s_cbranch_scc1 L_blk
    s_cmp_eq_u32 s12, 64
    s_cbranch_scc1 L_drain
    s_add_u32 s44, s48, s9
    s_addc_u32 s45, s49, 0
    s_mov_b32 s46, 0x100000
    s_mov_b32 s47, 0x20000
    v_mov_b32 v17, v21
    v_add_u32 v18, 3072, v22
    v_add_u32 v19, 6144, v21
    v_add_u32 v20, 9216, v22
    s_branch L_blk
L_drain:
    s_mov_b64 exec, 1
    v_mov_b32 v32, 64
    v_mov_b32 v33, 63
    v_mov_b32 v34, 62
    v_mov_b32 v35, 61
    v_mov_b32 v36, 60
    v_mov_b32 v37, 59
    s_waitcnt vmcnt(40)
    ds_max_u32 v6, v37 offset:29824
    s_waitcnt vmcnt(32)
    ds_max_u32 v6, v36 offset:29824
    s_waitcnt vmcnt(24)
    ds_max_u32 v6, v35 offset:29824
    s_waitcnt vmcnt(16)
    ds_max_u32 v6, v34 offset:29824
    s_waitcnt vmcnt(8)
    ds_max_u32 v6, v33 offset:29824
    s_waitcnt vmcnt(0)
    ds_max_u32 v6, v32 offset:29824
    s_branch L_done
L_hi_2:
    s_cmp_ge_u32 s15, 40
    s_waitcnt vmcnt(40)
    s_cbranch_scc1 L_w_1
    s_cmp_ge_u32 s15, 36
    s_waitcnt vmcnt(36)
    s_cbranch_scc1 L_w_1
    s_waitcnt vmcnt(32)
    s_branch L_w_1
L_hi_4:
    s_cmp_ge_u32 s15, 40
    s_waitcnt vmcnt(40)
    s_cbranch_scc1 L_w_3
    s_cmp_ge_u32 s15, 36
    s_waitcnt vmcnt(36)
    s_cbranch_scc1 L_w_3
    s_waitcnt vmcnt(32)
    s_branch L_w_3
L_full:
    ds_read_b32 v24, v23 offset:29840
    ds_read_b32 v25, v28 offset:29856
    s_waitcnt lgkmcnt(0)
    v_readlane_b32 s8, v24, s12
    s_nop 0
    s_cmp_ge_i32 s8, s12
    s_cbranch_scc1 L_go
    s_waitcnt vmcnt(0)
    v_lshrrev_b32 v8, v27, s14
    ds_write_b32 v26, v8 offset:29824
    s_mov_b32 s10, 0
L_slow:
    ds_read_b32 v24, v23 offset:29840
    ds_read_b32 v25, v28 offset:29856
    s_waitcnt lgkmcnt(0)
    v_readlane_b32 s8, v24, s12
    s_nop 0
    s_cmp_ge_i32 s8, s12
    s_cbranch_scc1 L_go2
    s_add_u32 s10, s10, 1
    s_cmp_lt_u32 s10, 4194304
    s_cbranch_scc1 L_slow
L_go2:
    s_branch L_go
L_cold_57:
    s_and_b32 s72, s9, 3
    s_lshr_b32 s73, s9, 5
    s_lshl2_add_u32 s73, s73, s72
    s_lshl_b32 s73, s73, 11
    s_bfe_u32 s74, s9, 0x30002
    s_lshl_b32 s74, s74, 8
    s_add_u32 s73, s73, s74
    s_add_u32 s73, s73, 0x280000
    s_add_u32 s74, s73, 0x40000
    v_lshlrev_b32 v212, 16, v2
    v_lshl_add_u32 v212, v5, 4, v212
    buffer_load_dwordx4 v[200:203], v212, s[84:87], s73 offen nt
    buffer_load_dwordx4 v[204:207], v212, s[84:87], s74 offen nt
    s_lshr_b32 s75, s9, 2
    s_lshl_b32 s75, s75, 8
    s_lshl4_add_u32 s75, s72, s75
    s_add_u32 s75, s75, 0xc000
    v_lshlrev_b32 v213, 6, v4
    buffer_load_dwordx4 v[208:211], v213, s[84:87], s75 offen nt
    s_sub_u32 s75, s75, 0x8000
    s_add_u32 s73, s73, 0x80000
    s_add_u32 s74, s74, 0x80000
    s_waitcnt vmcnt(0)
    buffer_store_dwordx4 v[200:203], v212, s[84:87], s73 offen sc1
    buffer_store_dwordx4 v[204:207], v212, s[84:87], s74 offen sc1
    s_mov_b64 exec, 0xf
    buffer_store_dwordx4 v[208:211], v213, s[84:87], s75 offen sc1
    s_mov_b64 exec, -1
    s_waitcnt vmcnt(0)
    s_lshr_b32 s72, s9, 5
    s_lshl_b32 s72, s72, 16
    s_and_b32 s73, s9, 31
    s_lshl_b32 s73, s73, 9
    s_add_u32 s72, s72, s73
    s_add_u32 s72, s72, 0x200000
    s_add_u32 s73, s72, 0x8000
    v_lshrrev_b32 v212, 5, v0
    v_lshlrev_b32 v212, 14, v212
    v_and_b32 v213, 31, v0
    v_lshl_add_u32 v212, v213, 4, v212
    s_mov_b32 s74, 0
L_rop_96:
    buffer_load_dwordx4 v[200:203], v212, s[84:87], s72 offen nt
    buffer_load_dwordx4 v[204:207], v212, s[84:87], s73 offen nt
    s_waitcnt vmcnt(0)
    v_cmp_ne_u64 vcc, s[70:71], v[202:203]
    v_cmp_ne_u64 s[92:93], s[70:71], v[206:207]
    s_nop 0
    s_or_b64 vcc, vcc, s[92:93]
    s_cbranch_scc0 L_ropk_97
    s_sleep 2
    s_add_u32 s74, s74, 1
    s_cmp_lt_u32 s74, 131072
    s_cbranch_scc1 L_rop_96
L_ropk_97:
    v_mov_b32 v202, s4
    v_mov_b32 v206, s4
    s_sub_u32 s72, s72, 0x180000
    s_sub_u32 s73, s73, 0x180000
    buffer_store_dwordx4 v[200:203], v212, s[84:87], s72 offen sc1
    buffer_store_dwordx4 v[204:207], v212, s[84:87], s73 offen sc1
    s_sub_u32 s75, s97, 0x180000
L_again_54:
    s_waitcnt vmcnt(0)
    ds_write_b64 v108, v[32:33] offset:0
    ds_write_b64 v108, v[36:37] offset:512
    ds_write_b64 v109, v[40:41] offset:1024
    ds_write_b64 v109, v[44:45] offset:1536
    v_cmp_ne_u64 vcc, s[4:5], v[34:35]
    v_cmp_ne_u64 s[72:73], s[70:71], v[34:35]
    s_nop 0
    s_and_b64 vcc, vcc, s[72:73]
    v_cmp_ne_u64 s[12:13], s[4:5], v[38:39]
    v_cmp_ne_u64 s[72:73], s[70:71], v[38:39]
    s_nop 0
    s_and_b64 s[12:13], s[12:13], s[72:73]
    v_cmp_ne_u64 s[88:89], s[4:5], v[42:43]
    v_cmp_ne_u64 s[72:73], s[70:71], v[42:43]
    s_nop 0
    s_and_b64 s[88:89], s[88:89], s[72:73]
    v_cmp_ne_u64 s[82:83], s[4:5], v[46:47]
    v_cmp_ne_u64 s[72:73], s[70:71], v[46:47]
    s_nop 0
    s_and_b64 s[82:83], s[82:83], s[72:73]
    s_or_b64 s[92:93], vcc, s[12:13]
    s_or_b64 s[94:95], s[88:89], s[82:83]
    s_or_b64 s[92:93], s[92:93], s[94:95]
    s_cbranch_scc0 L_ok_53
    s_waitcnt lgkmcnt(0)
    s_mov_b64 exec, vcc
    buffer_load_dwordx4 v[32:35], v1, s[84:87], s75 offen offset:0 sc1
    s_mov_b64 exec, s[12:13]
    buffer_load_dwordx4 v[36:39], v1, s[84:87], s75 offen offset:1024 sc1
    s_mov_b64 exec, s[88:89]
    buffer_load_dwordx4 v[40:43], v1, s[84:87], s75 offen offset:2048 sc1
    s_mov_b64 exec, s[82:83]
    buffer_load_dwordx4 v[44:47], v1, s[84:87], s75 offen offset:3072 sc1
    s_mov_b64 exec, -1
    s_waitcnt vmcnt(0)
    ds_write_b64 v108, v[32:33] offset:0
    ds_write_b64 v108, v[36:37] offset:512
    ds_write_b64 v109, v[40:41] offset:1024
    ds_write_b64 v109, v[44:45] offset:1536
    v_cmp_ne_u64 vcc, s[4:5], v[34:35]
    v_cmp_ne_u64 s[72:73], s[70:71], v[34:35]
    s_nop 0
    s_and_b64 vcc, vcc, s[72:73]
    v_cmp_ne_u64 s[12:13], s[4:5], v[38:39]
    v_cmp_ne_u64 s[72:73], s[70:71], v[38:39]
    s_nop 0
    s_and_b64 s[12:13], s[12:13], s[72:73]
    v_cmp_ne_u64 s[88:89], s[4:5], v[42:43]
    v_cmp_ne_u64 s[72:73], s[70:71], v[42:43]
    s_nop 0
    s_and_b64 s[88:89], s[88:89], s[72:73]
    v_cmp_ne_u64 s[82:83], s[4:5], v[46:47]
    v_cmp_ne_u64 s[72:73], s[70:71], v[46:47]
    s_nop 0
    s_and_b64 s[82:83], s[82:83], s[72:73]
    s_or_b64 s[92:93], vcc, s[12:13]
    s_or_b64 s[94:95], s[88:89], s[82:83]
    s_or_b64 s[92:93], s[92:93], s[94:95]
    s_cbranch_scc0 L_ok_53
    s_waitcnt lgkmcnt(0)
    s_mov_b64 exec, vcc
    buffer_load_dwordx4 v[32:35], v1, s[84:87], s97 offen offset:0 nt
    s_mov_b64 exec, s[12:13]
    buffer_load_dwordx4 v[36:39], v1, s[84:87], s97 offen offset:1024 nt
    s_mov_b64 exec, s[88:89]
    buffer_load_dwordx4 v[40:43], v1, s[84:87], s97 offen offset:2048 nt
    s_mov_b64 exec, s[82:83]
    buffer_load_dwordx4 v[44:47], v1, s[84:87], s97 offen offset:3072 nt
    s_mov_b64 exec, -1
    s_add_u32 s10, s10, 1
    s_cmp_lt_u32 s10, 131072
    s_cbranch_scc1 L_again_54
    s_waitcnt vmcnt(0)
    s_branch L_ok_53
L_q_cold:
    s_and_b32 s72, s9, 3
    s_lshr_b32 s73, s9, 5
    s_lshl2_add_u32 s73, s73, s72
    s_lshl_b32 s73, s73, 11
    s_bfe_u32 s74, s9, 0x30002
    s_lshl_b32 s74, s74, 8
    s_add_u32 s73, s73, s74
    s_add_u32 s73, s73, 0x280000
    s_add_u32 s74, s73, 0x40000
    v_lshlrev_b32 v212, 16, v2
    v_lshl_add_u32 v212, v5, 4, v212
    buffer_load_dwordx4 v[200:203], v212, s[84:87], s73 offen nt
    buffer_load_dwordx4 v[204:207], v212, s[84:87], s74 offen nt
    s_lshr_b32 s75, s9, 2
    s_lshl_b32 s75, s75, 8
    s_lshl4_add_u32 s75, s72, s75
    s_add_u32 s75, s75, 0xc000
    v_lshlrev_b32 v213, 6, v4
    buffer_load_dwordx4 v[208:211], v213, s[84:87], s75 offen nt
    s_sub_u32 s75, s75, 0x8000
    s_add_u32 s73, s73, 0x80000
    s_add_u32 s74, s74, 0x80000
    s_waitcnt vmcnt(0)
    buffer_store_dwordx4 v[200:203], v212, s[84:87], s73 offen sc1
    buffer_store_dwordx4 v[204:207], v212, s[84:87], s74 offen sc1
    s_mov_b64 exec, 0xf
    buffer_store_dwordx4 v[208:211], v213, s[84:87], s75 offen sc1
    s_mov_b64 exec, -1
L_q_far:
    s_waitcnt vmcnt(0)
    v_perm_b32 v80, v49, v48, s82
    v_perm_b32 v88, v51, v50, s83
    v_perm_b32 v81, v53, v52, s82
    v_perm_b32 v89, v55, v54, s83
    v_perm_b32 v82, v57, v56, s82
    v_perm_b32 v90, v59, v58, s83
    v_perm_b32 v83, v61, v60, s82
    v_perm_b32 v91, v63, v62, s83
    v_perm_b32 v84, v65, v64, s82
    v_perm_b32 v92, v67, v66, s83
    v_perm_b32 v85, v69, v68, s82
    v_perm_b32 v93, v71, v70, s83
    v_perm_b32 v86, v73, v72, s82
    v_perm_b32 v94, v75, v74, s83
    v_perm_b32 v87, v77, v76, s82
    v_perm_b32 v95, v79, v78, s83
    v_or_b32 v80, v80, v88
    v_or_b32 v81, v81, v89
    v_or_b32 v82, v82, v90
    v_or_b32 v83, v83, v91
    v_or_b32 v84, v84, v92
    v_or_b32 v85, v85, v93
    v_or_b32 v86, v86, v94
    v_or_b32 v87, v87, v95
    v_cmp_ne_u32 s[56:57], v30, v80
    v_cmp_ne_u32 s[58:59], v30, v81
    v_cmp_ne_u32 s[60:61], v30, v82
    v_cmp_ne_u32 s[62:63], v30, v83
    v_cmp_ne_u32 s[64:65], v30, v84
    v_cmp_ne_u32 s[66:67], v30, v85
    v_cmp_ne_u32 s[68:69], v30, v86
    v_cmp_ne_u32 s[70:71], v30, v87
    s_or_b64 s[92:93], s[56:57], s[58:59]
    s_or_b64 s[92:93], s[92:93], s[60:61]
    s_or_b64 s[92:93], s[92:93], s[62:63]
    s_or_b64 s[92:93], s[92:93], s[64:65]
    s_or_b64 s[92:93], s[92:93], s[66:67]
    s_or_b64 s[92:93], s[92:93], s[68:69]
    s_or_b64 s[92:93], s[92:93], s[70:71]
    s_cbranch_scc0 L_q_ok
    s_sleep 2
    s_add_u32 s6, s6, 0x80000
    s_add_u32 s7, s7, 0x80000
    s_cmp_eq_u64 s[56:57], 0
    s_cbranch_scc1 L_q_98
    buffer_load_dwordx4 v[48:51], v1, s[84:87], s6 offen offset:0 sc1
L_q_98:
    s_cmp_eq_u64 s[58:59], 0
    s_cbranch_scc1 L_q_99
    buffer_load_dwordx4 v[52:55], v1, s[84:87], s6 offen offset:1024 sc1
L_q_99:
    s_cmp_eq_u64 s[60:61], 0
    s_cbranch_scc1 L_q_100
    buffer_load_dwordx4 v[56:59], v1, s[84:87], s6 offen offset:2048 sc1
L_q_100:
    s_cmp_eq_u64 s[62:63], 0
    s_cbranch_scc1 L_q_101
    buffer_load_dwordx4 v[60:63], v1, s[84:87], s6 offen offset:3072 sc1
L_q_101:
    s_cmp_eq_u64 s[64:65], 0
    s_cbranch_scc1 L_q_102
    buffer_load_dwordx4 v[64:67], v1, s[84:87], s7 offen offset:0 sc1
L_q_102:
    s_cmp_eq_u64 s[66:67], 0
    s_cbranch_scc1 L_q_103
    buffer_load_dwordx4 v[68:71], v1, s[84:87], s7 offen offset:1024 sc1
L_q_103:
    s_cmp_eq_u64 s[68:69], 0
    s_cbranch_scc1 L_q_104
    buffer_load_dwordx4 v[72:75], v1, s[84:87], s7 offen offset:2048 sc1
L_q_104:
    s_cmp_eq_u64 s[70:71], 0
    s_cbranch_scc1 L_q_105
    buffer_load_dwordx4 v[76:79], v1, s[84:87], s7 offen offset:3072 sc1
L_q_105:
    s_waitcnt vmcnt(0)
    v_perm_b32 v80, v49, v48, s82
    v_perm_b32 v88, v51, v50, s83
    v_perm_b32 v81, v53, v52, s82
    v_perm_b32 v89, v55, v54, s83
    v_perm_b32 v82, v57, v56, s82
    v_perm_b32 v90, v59, v58, s83
    v_perm_b32 v83, v61, v60, s82
    v_perm_b32 v91, v63, v62, s83
    v_perm_b32 v84, v65, v64, s82
    v_perm_b32 v92, v67, v66, s83
    v_perm_b32 v85, v69, v68, s82
    v_perm_b32 v93, v71, v70, s83
    v_perm_b32 v86, v73, v72, s82
    v_perm_b32 v94, v75, v74, s83
    v_perm_b32 v87, v77, v76, s82
    v_perm_b32 v95, v79, v78, s83
    v_or_b32 v80, v80, v88
    v_or_b32 v81, v81, v89
    v_or_b32 v82, v82, v90
    v_or_b32 v83, v83, v91
    v_or_b32 v84, v84, v92
    v_or_b32 v85, v85, v93
    v_or_b32 v86, v86, v94
    v_or_b32 v87, v87, v95
    v_cmp_ne_u32 s[56:57], v30, v80
    v_cmp_ne_u32 s[58:59], v30, v81
    v_cmp_ne_u32 s[60:61], v30, v82
    v_cmp_ne_u32 s[62:63], v30, v83
    v_cmp_ne_u32 s[64:65], v30, v84
    v_cmp_ne_u32 s[66:67], v30, v85
    v_cmp_ne_u32 s[68:69], v30, v86
    v_cmp_ne_u32 s[70:71], v30, v87
    s_or_b64 s[92:93], s[56:57], s[58:59]
    s_or_b64 s[92:93], s[92:93], s[60:61]
    s_or_b64 s[92:93], s[92:93], s[62:63]
    s_or_b64 s[92:93], s[92:93], s[64:65]
    s_or_b64 s[92:93], s[92:93], s[66:67]
    s_or_b64 s[92:93], s[92:93], s[68:69]
    s_or_b64 s[92:93], s[92:93], s[70:71]
    s_cbranch_scc0 L_q_ok
    s_sleep 2
    s_sub_u32 s6, s6, 0x80000
    s_sub_u32 s7, s7, 0x80000
    s_cmp_eq_u64 s[56:57], 0
    s_cbranch_scc1 L_q_106
    buffer_load_dwordx4 v[48:51], v1, s[84:87], s6 offen offset:0 nt
L_q_106:
    s_cmp_eq_u64 s[58:59], 0
    s_cbranch_scc1 L_q_107
    buffer_load_dwordx4 v[52:55], v1, s[84:87], s6 offen offset:1024 nt
L_q_107:
    s_cmp_eq_u64 s[60:61], 0
    s_cbranch_scc1 L_q_108
    buffer_load_dwordx4 v[56:59], v1, s[84:87], s6 offen offset:2048 nt
L_q_108:
    s_cmp_eq_u64 s[62:63], 0
    s_cbranch_scc1 L_q_109
    buffer_load_dwordx4 v[60:63], v1, s[84:87], s6 offen offset:3072 nt
L_q_109:
    s_cmp_eq_u64 s[64:65], 0
    s_cbranch_scc1 L_q_110
    buffer_load_dwordx4 v[64:67], v1, s[84:87], s7 offen offset:0 nt
L_q_110:
    s_cmp_eq_u64 s[66:67], 0
    s_cbranch_scc1 L_q_111
    buffer_load_dwordx4 v[68:71], v1, s[84:87], s7 offen offset:1024 nt
L_q_111:
    s_cmp_eq_u64 s[68:69], 0
    s_cbranch_scc1 L_q_112
    buffer_load_dwordx4 v[72:75], v1, s[84:87], s7 offen offset:2048 nt
L_q_112:
    s_cmp_eq_u64 s[70:71], 0
    s_cbranch_scc1 L_q_113
    buffer_load_dwordx4 v[76:79], v1, s[84:87], s7 offen offset:3072 nt
L_q_113:
    s_add_u32 s10, s10, 1
    s_cmp_lt_u32 s10, 131072
    s_cbranch_scc1 L_q_far
    s_waitcnt vmcnt(0)
    s_branch L_q_ok
L_cold_80:
    s_and_b32 s72, s9, 3
    s_lshr_b32 s73, s9, 5
    s_lshl2_add_u32 s73, s73, s72
    s_lshl_b32 s73, s73, 11
    s_bfe_u32 s74, s9, 0x30002
    s_lshl_b32 s74, s74, 8
    s_add_u32 s73, s73, s74
    s_add_u32 s73, s73, 0x280000
    s_add_u32 s74, s73, 0x40000
    v_lshlrev_b32 v212, 16, v2
    v_lshl_add_u32 v212, v5, 4, v212
    buffer_load_dwordx4 v[200:203], v212, s[84:87], s73 offen nt
    buffer_load_dwordx4 v[204:207], v212, s[84:87], s74 offen nt
    s_lshr_b32 s75, s9, 2
    s_lshl_b32 s75, s75, 8
    s_lshl4_add_u32 s75, s72, s75
    s_add_u32 s75, s75, 0xc000
    v_lshlrev_b32 v213, 6, v4
    buffer_load_dwordx4 v[208:211], v213, s[84:87], s75 offen nt
    s_sub_u32 s75, s75, 0x8000
    s_add_u32 s73, s73, 0x80000
    s_add_u32 s74, s74, 0x80000
    s_waitcnt vmcnt(0)
    buffer_store_dwordx4 v[200:203], v212, s[84:87], s73 offen sc1
    buffer_store_dwordx4 v[204:207], v212, s[84:87], s74 offen sc1
    s_mov_b64 exec, 0xf
    buffer_store_dwordx4 v[208:211], v213, s[84:87], s75 offen sc1
    s_mov_b64 exec, -1
    s_sub_u32 s75, s100, 0x8000
L_again_77:
    s_waitcnt vmcnt(0)
    v_cmp_ne_u64 vcc, s[4:5], v[34:35]
    s_nop 0
    s_cmp_lg_u64 vcc, 0
    s_cbranch_scc0 L_ok_76
    s_sleep 8
    s_mov_b64 exec, vcc
    buffer_load_dwordx4 v[32:35], v9, s[84:87], s75 offen sc1
    s_mov_b64 exec, -1
    s_waitcnt vmcnt(0)
    v_cmp_ne_u64 vcc, s[4:5], v[34:35]
    s_nop 0
    s_cmp_lg_u64 vcc, 0
    s_cbranch_scc0 L_ok_76
    s_sleep 8
    s_mov_b64 exec, vcc
    buffer_load_dwordx4 v[32:35], v9, s[84:87], s100 offen nt
    s_mov_b64 exec, -1
    s_add_u32 s10, s10, 1
    s_cmp_lt_u32 s10, 131072
    s_cbranch_scc1 L_again_77
    s_waitcnt vmcnt(0)
    s_branch L_ok_76
L_cold_89:
    s_and_b32 s72, s9, 3
    s_lshr_b32 s73, s9, 5
    s_lshl2_add_u32 s73, s73, s72
    s_lshl_b32 s73, s73, 11
    s_bfe_u32 s74, s9, 0x30002
    s_lshl_b32 s74, s74, 8
    s_add_u32 s73, s73, s74
    s_add_u32 s73, s73, 0x280000
    s_add_u32 s74, s73, 0x40000
    v_lshlrev_b32 v212, 16, v2
    v_lshl_add_u32 v212, v5, 4, v212
    buffer_load_dwordx4 v[200:203], v212, s[84:87], s73 offen nt
    buffer_load_dwordx4 v[204:207], v212, s[84:87], s74 offen nt
    s_lshr_b32 s75, s9, 2
    s_lshl_b32 s75, s75, 8
    s_lshl4_add_u32 s75, s72, s75
    s_add_u32 s75, s75, 0xc000
    v_lshlrev_b32 v213, 6, v4
    buffer_load_dwordx4 v[208:211], v213, s[84:87], s75 offen nt
    s_sub_u32 s75, s75, 0x8000
    s_add_u32 s73, s73, 0x80000
    s_add_u32 s74, s74, 0x80000
    s_waitcnt vmcnt(0)
    buffer_store_dwordx4 v[200:203], v212, s[84:87], s73 offen sc1
    buffer_store_dwordx4 v[204:207], v212, s[84:87], s74 offen sc1
    s_mov_b64 exec, 0xf
    buffer_store_dwordx4 v[208:211], v213, s[84:87], s75 offen sc1
    s_mov_b64 exec, -1
    s_waitcnt vmcnt(0)
    s_lshr_b32 s72, s9, 5
    s_lshl_b32 s72, s72, 16
    s_and_b32 s73, s9, 31
    s_lshl_b32 s73, s73, 9
    s_add_u32 s72, s72, s73
    s_add_u32 s72, s72, 0x200000
    s_add_u32 s73, s72, 0x8000
    v_lshrrev_b32 v212, 5, v0
    v_lshlrev_b32 v212, 14, v212
    v_and_b32 v213, 31, v0
    v_lshl_add_u32 v212, v213, 4, v212
    s_mov_b32 s74, 0
L_rop_114:
    buffer_load_dwordx4 v[200:203], v212, s[84:87], s72 offen nt
    buffer_load_dwordx4 v[204:207], v212, s[84:87], s73 offen nt
    s_waitcnt vmcnt(0)
    v_cmp_ne_u64 vcc, s[70:71], v[202:203]
    v_cmp_ne_u64 s[92:93], s[70:71], v[206:207]
    s_nop 0
    s_or_b64 vcc, vcc, s[92:93]
    s_cbranch_scc0 L_ropk_115
    s_sleep 2
    s_add_u32 s74, s74, 1
    s_cmp_lt_u32 s74, 131072
    s_cbranch_scc1 L_rop_114
L_ropk_115:
    v_mov_b32 v202, s4
    v_mov_b32 v206, s4
    s_sub_u32 s72, s72, 0x180000
    s_sub_u32 s73, s73, 0x180000
    buffer_store_dwordx4 v[200:203], v212, s[84:87], s72 offen sc1
    buffer_store_dwordx4 v[204:207], v212, s[84:87], s73 offen sc1
    s_sub_u32 s75, s7, 0x180000
L_again_86:
    s_waitcnt vmcnt(0)
    ds_write_b64 v13, v[32:33] offset:0
    ds_write_b64 v13, v[36:37] offset:512
    ds_write_b64 v14, v[40:41] offset:1024
    ds_write_b64 v14, v[44:45] offset:1536
    v_cmp_ne_u64 vcc, s[4:5], v[34:35]
    v_cmp_ne_u64 s[72:73], s[70:71], v[34:35]
    s_nop 0
    s_and_b64 vcc, vcc, s[72:73]
    v_cmp_ne_u64 s[12:13], s[4:5], v[38:39]
    v_cmp_ne_u64 s[72:73], s[70:71], v[38:39]
    s_nop 0
    s_and_b64 s[12:13], s[12:13], s[72:73]
    v_cmp_ne_u64 s[88:89], s[4:5], v[42:43]
    v_cmp_ne_u64 s[72:73], s[70:71], v[42:43]
    s_nop 0
    s_and_b64 s[88:89], s[88:89], s[72:73]
    v_cmp_ne_u64 s[82:83], s[4:5], v[46:47]
    v_cmp_ne_u64 s[72:73], s[70:71], v[46:47]
    s_nop 0
    s_and_b64 s[82:83], s[82:83], s[72:73]
    s_or_b64 s[92:93], vcc, s[12:13]
    s_or_b64 s[94:95], s[88:89], s[82:83]
    s_or_b64 s[92:93], s[92:93], s[94:95]
    s_cbranch_scc0 L_ok_85
    s_waitcnt lgkmcnt(0)
    s_mov_b64 exec, vcc
    buffer_load_dwordx4 v[32:35], v1, s[84:87], s75 offen offset:0 sc1
    s_mov_b64 exec, s[12:13]
    buffer_load_dwordx4 v[36:39], v1, s[84:87], s75 offen offset:1024 sc1
    s_mov_b64 exec, s[88:89]
    buffer_load_dwordx4 v[40:43], v1, s[84:87], s75 offen offset:2048 sc1
    s_mov_b64 exec, s[82:83]
    buffer_load_dwordx4 v[44:47], v1, s[84:87], s75 offen offset:3072 sc1
    s_mov_b64 exec, -1
    s_waitcnt vmcnt(0)
    ds_write_b64 v13, v[32:33] offset:0
    ds_write_b64 v13, v[36:37] offset:512
    ds_write_b64 v14, v[40:41] offset:1024
    ds_write_b64 v14, v[44:45] offset:1536
    v_cmp_ne_u64 vcc, s[4:5], v[34:35]
    v_cmp_ne_u64 s[72:73], s[70:71], v[34:35]
    s_nop 0
    s_and_b64 vcc, vcc, s[72:73]
    v_cmp_ne_u64 s[12:13], s[4:5], v[38:39]
    v_cmp_ne_u64 s[72:73], s[70:71], v[38:39]
    s_nop 0
    s_and_b64 s[12:13], s[12:13], s[72:73]
    v_cmp_ne_u64 s[88:89], s[4:5], v[42:43]
    v_cmp_ne_u64 s[72:73], s[70:71], v[42:43]
    s_nop 0
    s_and_b64 s[88:89], s[88:89], s[72:73]
    v_cmp_ne_u64 s[82:83], s[4:5], v[46:47]
    v_cmp_ne_u64 s[72:73], s[70:71], v[46:47]
    s_nop 0
    s_and_b64 s[82:83], s[82:83], s[72:73]
    s_or_b64 s[92:93], vcc, s[12:13]
    s_or_b64 s[94:95], s[88:89], s[82:83]
    s_or_b64 s[92:93], s[92:93], s[94:95]
    s_cbranch_scc0 L_ok_85
    s_waitcnt lgkmcnt(0)
    s_mov_b64 exec, vcc
    buffer_load_dwordx4 v[32:35], v1, s[84:87], s7 offen offset:0 nt
    s_mov_b64 exec, s[12:13]
    buffer_load_dwordx4 v[36:39], v1, s[84:87], s7 offen offset:1024 nt
    s_mov_b64 exec, s[88:89]
    buffer_load_dwordx4 v[40:43], v1, s[84:87], s7 offen offset:2048 nt
    s_mov_b64 exec, s[82:83]
    buffer_load_dwordx4 v[44:47], v1, s[84:87], s7 offen offset:3072 nt
    s_mov_b64 exec, -1
    s_add_u32 s10, s10, 1
    s_cmp_lt_u32 s10, 131072
    s_cbranch_scc1 L_again_86
    s_waitcnt vmcnt(0)
    s_branch L_ok_85
.section .rodata,"a"
.p2align 6
.amdhsa_kernel recurrent_scan__gqa_block_cached__mixer_token_mlp__decode_kernel
  .amdhsa_next_free_vgpr 256
  .amdhsa_next_free_sgpr 102
  .amdhsa_accum_offset 256
  .amdhsa_group_segment_fixed_size 0
  .amdhsa_kernarg_size 104
  .amdhsa_user_sgpr_count 2
  .amdhsa_user_sgpr_kernarg_segment_ptr 1
  .amdhsa_system_sgpr_workgroup_id_x 1
.end_amdhsa_kernel
```
